```python
import torch

def _softmax(x, axis=-1):
    return torch.softmax(x, dim=axis)
def _gelu(x):
    return torch.nn.functional.gelu(x, approximate="tanh")
def _silu(x):
    return torch.nn.functional.silu(x)
def _sigmoid(x):
    return torch.sigmoid(x)
def _layernorm(x, axis=-1, eps=1e-5):
    m = x.mean(dim=axis, keepdim=True)
    v = x.var(dim=axis, keepdim=True, unbiased=False)
    return (x - m) / torch.sqrt(v + eps)
def _scatter_add(tgt, idx, src, axis=0):
    return tgt.clone().index_add_(axis, idx, src)
def _segment_sum(src, seg, n):
    out = torch.zeros((n,) + src.shape[1:], dtype=src.dtype)
    return out.index_add_(0, seg, src)
def _pad(x, pw):
    flat = tuple(v for pair in reversed(pw) for v in pair)
    return torch.nn.functional.pad(x, flat)

kernel_name = 'parallel_sum__ssm_conv_s4d__glu_gated_swiglu__prompt'

def setup_inputs():

    _w = (lambda a: (lambda t: t.to(torch.bfloat16) if t.is_floating_point() else t)(torch.as_tensor(a)))
    def _A_setup():
        Bsz, L, D, N = 1, 2048, 512, 128
        return {
            "u": _w((lambda *s: torch.randn(*s, dtype=torch.bfloat16) * 0.05)(Bsz, L, D)),
            "log_A_real": _w((lambda *s: torch.randn(*s, dtype=torch.bfloat16) * 3.2)(D, N) * 0.5),
            "A_imag": _w((lambda *s: torch.randn(*s, dtype=torch.bfloat16) * 0.05)(D, N) * 3.14),
            "C_real": _w((lambda *s: torch.randn(*s, dtype=torch.bfloat16) * 0.1)(D, N) / N ** 0.5),
            "C_imag": _w((lambda *s: torch.randn(*s, dtype=torch.bfloat16) * 0.2)(D, N) / N ** 0.5),
            "log_dt": _w((lambda *s: torch.randn(*s, dtype=torch.bfloat16) * 0.05)(D) * 0.5 - 4.0),
            "D_skip": _w((lambda *s: torch.randn(*s, dtype=torch.bfloat16) * 0.05)(D)),
        }
    _A_in = _A_setup()

    def _B_setup():
        B, S, D, F = 1, 2048, 512, 1792
        return {
            "x": _w((lambda *s: torch.randn(*s, dtype=torch.bfloat16) * 0.05)(B, S, D)),
            "w1": _w((lambda *s: torch.randn(*s, dtype=torch.bfloat16) * 0.4)(D, F) * (2.0 / D) ** 0.5),
            "w3": _w((lambda *s: torch.randn(*s, dtype=torch.bfloat16) * 0.4)(D, F) * (2.0 / D) ** 0.5),
            "w2": _w((lambda *s: torch.randn(*s, dtype=torch.bfloat16) * 0.4)(F, D) * (2.0 / F) ** 0.5),
        }
    _B_in = _B_setup()

    return {
        "A_u": _A_in["u"],
        "A_log_A_real": _A_in["log_A_real"],
        "A_A_imag": _A_in["A_imag"],
        "A_C_real": _A_in["C_real"],
        "A_C_imag": _A_in["C_imag"],
        "A_log_dt": _A_in["log_dt"],
        "A_D_skip": _A_in["D_skip"],
        "B_x": _B_in["x"],
        "B_w1": _B_in["w1"],
        "B_w3": _B_in["w3"],
        "B_w2": _B_in["w2"],
    }

def reference(A_u, A_log_A_real, A_A_imag, A_C_real, A_C_imag, A_log_dt, A_D_skip, B_x, B_w1, B_w3, B_w2):
    def _A_ref(u, log_A_real, A_imag, C_real, C_imag, log_dt, D_skip):
        L = u.shape[1]
        dt = torch.exp(log_dt)
        A = -torch.exp(log_A_real) + 1j * A_imag
        C = (C_real + 1j * C_imag) * dt[:, None]
        pos = (lambda x, dt: x.to(dt))(torch.arange(L), log_dt.dtype)
        P = torch.exp((A * dt[:, None])[:, :, None] * pos[None, None, :])
        K = 2.0 * torch.einsum("dn,dnl->dl", C, P).real
        L2 = 2 * L
        u_t = (lambda x, *d: x.permute(*d))(u, 0, 2, 1)
        Kf = (lambda x, *a, **k: torch.fft.rfft(x.float(), *a, **k))(K, L2)
        Uf = (lambda x, *a, **k: torch.fft.rfft(x.float(), *a, **k))(u_t, L2)
        y = (lambda x, *a, **k: torch.fft.irfft(x, *a, **k).to(torch.bfloat16))(Uf * Kf[None, :, :], L2)[:, :, :L]
        y = (lambda x, *d: x.permute(*d))(y, 0, 2, 1)
        return y + u * D_skip[None, None, :]

    def _B_ref(x, w1, w3, w2):
        gate = torch.einsum("bsd,df->bsf", x, w1)
        up = torch.einsum("bsd,df->bsf", x, w3)
        h = _silu(gate) * up
        out = torch.einsum("bsf,fd->bsd", h, w2)
        return out

    x = A_u
    xn = _layernorm(x, axis=-1)
    return x + _A_ref(xn, A_log_A_real, A_A_imag, A_C_real, A_C_imag, A_log_dt, A_D_skip) + _B_ref(xn, B_w1, B_w3, B_w2)
```

```asm
; @launch grid=(256,1,1) block=(512,1,1) lds=163840
.amdgcn_target "amdgcn-amd-amdhsa--gfx950"
.text
.globl parallel_sum__ssm_conv_s4d__glu_gated_swiglu__prompt_kernel
.p2align 8
.type parallel_sum__ssm_conv_s4d__glu_gated_swiglu__prompt_kernel,@function
parallel_sum__ssm_conv_s4d__glu_gated_swiglu__prompt_kernel:
    s_cmp_ge_u32 s2, 256
    s_cbranch_scc1 L_END
    s_load_dwordx16 s[64:79], s[0:1], 0
    s_load_dwordx8 s[80:87], s[0:1], 64
    s_load_dwordx4 s[88:91], s[0:1], 96
    s_getpc_b64 s[92:93]
    s_lshr_b32 s54, s2, 3
    s_and_b32 s55, s54, 3
    s_and_b32 s53, s54, 7
    s_min_u32 s53, s53, 4
    s_lshl_b32 s53, s53, 13
    v_lshlrev_b32 v3, 4, v0
    v_add_u32 v3, s53, v3
    global_load_dwordx4 v[252:255], v3, s[92:93]
    v_and_b32 v1, 63, v0
    v_lshrrev_b32 v3, 6, v0
    v_lshlrev_b32 v2, 2, v1
    v_readfirstlane_b32 s32, v3
    s_and_b32 s53, s2, 7
    s_and_b32 s57, s2, 3
    s_lshl_b32 s57, s57, 3
    s_and_b32 s56, s2, 4
    s_add_u32 s57, s57, s56
    s_add_u32 s57, s57, s55
    s_lshr_b32 s58, s2, 5
    s_xor_b32 s58, s58, 3
    s_and_b32 s52, s32, 3
    s_lshl_b32 s52, s52, 10
    s_bfe_u32 s56, s32, 0x10001
    s_lshl_b32 s56, s56, 8
    s_lshl_b32 s62, s2, 9
    s_add_u32 s56, s56, s62
    v_add_u32 v13, s56, v2
    s_lshl_b32 s62, s2, 2
    s_sub_u32 s34, s54, 4
    s_lshr_b32 s56, s34, 2
    s_and_b32 s33, s53, 3
    s_lshl_b32 s35, s33, 1
    s_lshl_b32 s33, s33, 2
    s_add_u32 s33, s33, s55
    s_lshr_b32 s34, s53, 2
    s_mul_i32 s34, s34, 7
    s_add_u32 s34, s34, s56
    s_and_b32 s56, s2, 4
    s_add_u32 s35, s35, s56
    s_waitcnt lgkmcnt(0)
    global_load_dword v240, v13, s[66:67]
    global_load_dword v241, v13, s[68:69]
    global_load_dword v242, v13, s[70:71]
    global_load_dword v243, v13, s[72:73]
    s_load_dword s59, s[74:75], s62
    s_load_dword s63, s[76:77], s62
    s_mov_b32 s4, s64
    s_mov_b32 s5, s65
    s_mov_b32 s6, 0x200000
    s_mov_b32 s7, 0x00020000
    s_mov_b32 s8, s80
    s_mov_b32 s9, s81
    s_mov_b32 s10, 0x1c0000
    s_mov_b32 s11, 0x00020000
    s_mov_b32 s12, s82
    s_mov_b32 s13, s83
    s_mov_b32 s14, 0x1c0000
    s_mov_b32 s15, 0x00020000
    s_mov_b32 s16, s84
    s_mov_b32 s17, s85
    s_mov_b32 s18, 0x1c0000
    s_mov_b32 s19, 0x00020000
    s_mov_b32 s20, s86
    s_mov_b32 s21, s87
    s_mov_b32 s22, 0x200000
    s_mov_b32 s23, 0x00020000
    s_mov_b32 s24, s88
    s_mov_b32 s25, s89
    s_mov_b32 s26, 0x100
    s_mov_b32 s27, 0x00020000
    s_mov_b32 s28, s90
    s_mov_b32 s29, s91
    s_mov_b32 s30, 0x1000000
    s_mov_b32 s31, 0x00020000
    s_or_b32 s62, s2, s32
    s_cmp_lg_u32 s62, 0
    s_cbranch_scc1 NW_1
    s_memrealtime s[96:97]
    s_waitcnt lgkmcnt(0)
    s_or_b32 s62, s96, 1
    v_mov_b32 v14, s62
    s_mov_b64 exec, 1
    buffer_store_dword v14, v2, s[24:27], 0 offen sc1
    s_mov_b64 exec, -1
NW_1:
    s_cmp_lt_u32 s2, 32
    s_cbranch_scc1 L_AUX
    s_cmp_lt_u32 s32, 4
    s_cbranch_scc1 L_G
    s_lshl_b32 s82, s34, 8
    s_lshl_b32 s83, s33, 17
    s_add_u32 s44, s35, 0
    s_and_b32 s44, s44, 7
    s_mul_i32 s36, s44, 229376
    s_add_u32 s36, s36, s82
    s_lshl_b32 s44, s44, 7
    s_add_u32 s44, s44, s83
    v_lshrrev_b32 v13, 4, v1
    s_bfe_u32 s55, s32, 0x10001
    s_lshl_b32 s55, s55, 2
    v_or_b32 v14, s55, v13
    v_lshlrev_b32 v14, 1, v14
    v_and_b32 v3, 15, v1
    v_xor_b32 v3, v3, v14
    v_lshlrev_b32 v3, 4, v3
    v_bfe_u32 v13, v0, 4, 4
    v_mul_u32_u24 v14, 3584, v13
    v_add_u32 v3, v3, v14
    v_add_u32 v4, 57344, v3
    v_add_u32 v5, 114688, v3
    v_add_u32 v6, 172032, v3
    v_xor_b32 v13, v13, v1
    v_and_b32 v13, 7, v13
    v_bfe_u32 v14, v0, 3, 5
    v_lshlrev_b32 v14, 10, v14
    v_lshl_add_u32 v7, v13, 4, v14
    s_add_u32 m0, s52, 0
    s_add_u32 s56, s44, 0
    buffer_load_dwordx4 v7, s[4:7], s56 offen lds
    s_add_u32 m0, s52, 4096
    s_add_u32 s56, s44, 32768
    buffer_load_dwordx4 v7, s[4:7], s56 offen lds
    s_add_u32 m0, s52, 8192
    s_add_u32 s56, s44, 65536
    buffer_load_dwordx4 v7, s[4:7], s56 offen lds
    s_add_u32 m0, s52, 12288
    s_add_u32 s56, s44, 98304
    buffer_load_dwordx4 v7, s[4:7], s56 offen lds
    s_add_u32 m0, s52, 49152
    s_nop 0
    buffer_load_dwordx4 v3, s[8:11], s36 offen lds
    s_add_u32 m0, s52, 53248
    s_nop 0
    buffer_load_dwordx4 v4, s[8:11], s36 offen lds
    s_add_u32 m0, s52, 57344
    s_nop 0
    buffer_load_dwordx4 v3, s[12:15], s36 offen lds
    s_add_u32 m0, s52, 61440
    s_nop 0
    buffer_load_dwordx4 v4, s[12:15], s36 offen lds
    s_add_u32 m0, s52, 65536
    s_nop 0
    buffer_load_dwordx4 v5, s[8:11], s36 offen lds
    s_add_u32 m0, s52, 69632
    s_nop 0
    buffer_load_dwordx4 v6, s[8:11], s36 offen lds
    s_add_u32 m0, s52, 73728
    s_nop 0
    buffer_load_dwordx4 v5, s[12:15], s36 offen lds
    s_add_u32 m0, s52, 77824
    s_nop 0
    buffer_load_dwordx4 v6, s[12:15], s36 offen lds
    s_add_u32 s45, s35, 1
    s_and_b32 s45, s45, 7
    s_mul_i32 s37, s45, 229376
    s_add_u32 s37, s37, s82
    s_lshl_b32 s45, s45, 7
    s_add_u32 s45, s45, s83
    s_and_b32 s53, s32, 3
    s_mov_b32 s54, 114688
    s_cmp_eq_u32 s53, 1
    s_cmov_b32 s54, 130192
    s_cmp_eq_u32 s53, 2
    s_cmov_b32 s54, 32768
    s_cmp_eq_u32 s53, 3
    s_cmov_b32 s54, 145696
    v_add_u32 v12, s54, v2
    s_and_b32 s54, s53, 1
    s_lshl_b32 s54, s54, 4
    s_sub_u32 s84, 16, s54
    s_lshr_b32 s54, s53, 1
    s_lshl_b32 s54, s54, 4
    s_sub_u32 s85, 16, s54
    v_and_b32 v13, 15, v1
    v_lshrrev_b32 v14, 4, v1
    v_mul_u32_u24 v198, 272, v13
    v_lshl_add_u32 v198, v14, 4, v198
    s_bitcmp1_b32 s32, 1
    s_mov_b32 s53, 114688
    s_cmov_b32 s53, 32768
    s_mov_b32 s54, 130192
    s_cmov_b32 s54, 145696
    v_add_u32 v199, s54, v198
    v_add_u32 v198, s53, v198
    s_and_b32 s53, s32, 1
    s_mul_i32 s53, s53, 8704
    v_add_u32 v235, s53, v198
    v_add_u32 v236, s53, v199
    v_bfe_u32 v13, v1, 2, 2
    v_lshrrev_b32 v14, 4, v1
    v_and_b32 v10, 1, v14
    v_lshl_or_b32 v10, v10, 2, v13
    s_and_b32 s56, s33, 3
    s_lshl_b32 s56, s56, 1
    v_xor_b32 v10, s56, v10
    v_lshlrev_b32 v10, 5, v10
    v_lshl_add_u32 v13, v14, 3, v13
    v_lshl_add_u32 v10, v13, 8, v10
    v_and_b32 v13, 3, v1
    v_lshl_add_u32 v10, v13, 3, v10
    s_bfe_u32 s55, s32, 0x10001
    s_lshl_b32 s55, s55, 13
    s_add_u32 s55, s55, 49152
    v_add_u32 v10, s55, v10
    s_and_b32 s55, s32, 1
    s_lshl_b32 s55, s55, 5
    v_xor_b32 v10, s55, v10
    v_mov_b32 v112, 0x3f803f80
    v_mov_b32 v113, 0x3f803f80
    v_mov_b32 v114, 0x3f803f80
    v_mov_b32 v115, 0x3f803f80
    s_waitcnt vmcnt(12) lgkmcnt(0)
    s_lshl_b32 s55, s59, s85
    s_and_b32 s55, s55, 0xffff0000
    v_lshlrev_b32 v16, s84, v240
    v_lshlrev_b32 v17, s84, v241
    v_lshlrev_b32 v18, s84, v242
    v_lshlrev_b32 v19, s84, v243
    v_and_b32 v16, 0xffff0000, v16
    v_and_b32 v17, 0xffff0000, v17
    v_and_b32 v18, 0xffff0000, v18
    v_and_b32 v19, 0xffff0000, v19
    v_mov_b32 v20, 0x3fb8aa3b
    v_mul_f32 v20, s55, v20
    v_mul_f32 v21, 0x3fb8aa3b, v16
    v_exp_f32 v20, v20
    v_exp_f32 v21, v21
    s_nop 0
    v_cvt_pk_bf16_f32 v20, v20, v20
    v_lshlrev_b32 v20, 16, v20
    v_cvt_pk_bf16_f32 v21, v21, v21
    v_lshlrev_b32 v21, 16, v21
    v_mul_f32 v21, v21, v20
    v_mul_f32 v22, v17, v20
    v_mul_f32 v21, 0xbfb8aa3b, v21
    v_mul_f32 v22, 0x3e22f983, v22
    v_mul_f32 v24, 2.0, v21
    v_mul_f32 v25, 2.0, v22
    v_mul_f32 v26, 0x43000000, v21
    v_mul_f32 v27, 0x43000000, v22
    v_mul_f32 v28, 0x44800000, v21
    v_mul_f32 v29, 0x44800000, v22
    v_exp_f32 v24, v24
    v_fract_f32 v25, v25
    v_exp_f32 v26, v26
    v_fract_f32 v27, v27
    v_exp_f32 v28, v28
    v_fract_f32 v29, v29
    v_cos_f32 v30, v25
    v_sin_f32 v31, v25
    v_cos_f32 v32, v27
    v_sin_f32 v33, v27
    v_cos_f32 v34, v29
    v_sin_f32 v35, v29
    s_nop 0
    v_mul_f32 v30, v30, v24
    v_mul_f32 v31, v31, v24
    v_mul_f32 v32, v32, v26
    v_mul_f32 v33, v33, v26
    v_mul_f32 v34, v34, v28
    v_mul_f32 v35, v35, v28
    v_pk_mul_f32 v[40:41], v[32:33], v[32:33] op_sel:[0,0] op_sel_hi:[0,1]
    v_cvt_pk_bf16_f32 v74, v34, v35
    v_pk_mul_f32 v[36:37], v[30:31], v[30:31] op_sel:[0,0] op_sel_hi:[0,1]
    v_pk_fma_f32 v[40:41], v[32:33], v[32:33], v[40:41] op_sel:[1,1,0] op_sel_hi:[1,0,1] neg_lo:[0,1,0]
    ds_write_b32 v12, v74 offset:13056
    v_pk_fma_f32 v[36:37], v[30:31], v[30:31], v[36:37] op_sel:[1,1,0] op_sel_hi:[1,0,1] neg_lo:[0,1,0]
    v_cvt_pk_bf16_f32 v72, v40, v41
    v_pk_mul_f32 v[52:53], v[34:35], v[32:33] op_sel:[0,0] op_sel_hi:[0,1]
    v_pk_mul_f32 v[38:39], v[36:37], v[30:31] op_sel:[0,0] op_sel_hi:[0,1]
    ds_write_b32 v12, v72 offset:8704
    v_pk_fma_f32 v[52:53], v[34:35], v[32:33], v[52:53] op_sel:[1,1,0] op_sel_hi:[1,0,1] neg_lo:[0,1,0]
    v_pk_fma_f32 v[38:39], v[36:37], v[30:31], v[38:39] op_sel:[1,1,0] op_sel_hi:[1,0,1] neg_lo:[0,1,0]
    v_pk_mul_f32 v[42:43], v[40:41], v[32:33] op_sel:[0,0] op_sel_hi:[0,1]
    v_cvt_pk_bf16_f32 v75, v52, v53
    v_pk_fma_f32 v[42:43], v[40:41], v[32:33], v[42:43] op_sel:[1,1,0] op_sel_hi:[1,0,1] neg_lo:[0,1,0]
    ds_write_b32 v12, v75 offset:13328
    v_cvt_pk_bf16_f32 v73, v42, v43
    v_pk_mul_f32 v[54:55], v[52:53], v[32:33] op_sel:[0,0] op_sel_hi:[0,1]
    ds_write_b32 v12, v73 offset:9792
    v_pk_fma_f32 v[54:55], v[52:53], v[32:33], v[54:55] op_sel:[1,1,0] op_sel_hi:[1,0,1] neg_lo:[0,1,0]
    v_pk_mul_f32 v[44:45], v[42:43], v[32:33] op_sel:[0,0] op_sel_hi:[0,1]
    v_cvt_pk_bf16_f32 v74, v54, v55
    v_pk_fma_f32 v[44:45], v[42:43], v[32:33], v[44:45] op_sel:[1,1,0] op_sel_hi:[1,0,1] neg_lo:[0,1,0]
    ds_write_b32 v12, v74 offset:13600
    v_cvt_pk_bf16_f32 v72, v44, v45
    v_pk_mul_f32 v[56:57], v[54:55], v[32:33] op_sel:[0,0] op_sel_hi:[0,1]
    ds_write_b32 v12, v72 offset:10880
    v_pk_fma_f32 v[56:57], v[54:55], v[32:33], v[56:57] op_sel:[1,1,0] op_sel_hi:[1,0,1] neg_lo:[0,1,0]
    v_pk_mul_f32 v[46:47], v[44:45], v[32:33] op_sel:[0,0] op_sel_hi:[0,1]
    v_cvt_pk_bf16_f32 v75, v56, v57
    v_pk_fma_f32 v[46:47], v[44:45], v[32:33], v[46:47] op_sel:[1,1,0] op_sel_hi:[1,0,1] neg_lo:[0,1,0]
    ds_write_b32 v12, v75 offset:13872
    v_cvt_pk_bf16_f32 v73, v46, v47
    v_pk_mul_f32 v[58:59], v[56:57], v[32:33] op_sel:[0,0] op_sel_hi:[0,1]
    ds_write_b32 v12, v73 offset:11152
    v_pk_fma_f32 v[58:59], v[56:57], v[32:33], v[58:59] op_sel:[1,1,0] op_sel_hi:[1,0,1] neg_lo:[0,1,0]
    v_pk_mul_f32 v[48:49], v[46:47], v[32:33] op_sel:[0,0] op_sel_hi:[0,1]
    v_cvt_pk_bf16_f32 v74, v58, v59
    v_pk_fma_f32 v[48:49], v[46:47], v[32:33], v[48:49] op_sel:[1,1,0] op_sel_hi:[1,0,1] neg_lo:[0,1,0]
    ds_write_b32 v12, v74 offset:14144
    v_cvt_pk_bf16_f32 v72, v48, v49
    v_pk_mul_f32 v[60:61], v[58:59], v[32:33] op_sel:[0,0] op_sel_hi:[0,1]
    ds_write_b32 v12, v72 offset:11424
    v_pk_fma_f32 v[60:61], v[58:59], v[32:33], v[60:61] op_sel:[1,1,0] op_sel_hi:[1,0,1] neg_lo:[0,1,0]
    v_pk_mul_f32 v[50:51], v[48:49], v[32:33] op_sel:[0,0] op_sel_hi:[0,1]
    v_cvt_pk_bf16_f32 v75, v60, v61
    v_pk_fma_f32 v[50:51], v[48:49], v[32:33], v[50:51] op_sel:[1,1,0] op_sel_hi:[1,0,1] neg_lo:[0,1,0]
    ds_write_b32 v12, v75 offset:14416
    v_cvt_pk_bf16_f32 v73, v50, v51
    v_pk_mul_f32 v[62:63], v[60:61], v[32:33] op_sel:[0,0] op_sel_hi:[0,1]
    ds_write_b32 v12, v73 offset:11696
    v_pk_fma_f32 v[62:63], v[60:61], v[32:33], v[62:63] op_sel:[1,1,0] op_sel_hi:[1,0,1] neg_lo:[0,1,0]
    v_cvt_pk_bf16_f32 v74, v62, v63
    ds_write_b32 v12, v74 offset:14688
    v_pk_mul_f32 v[64:65], v[62:63], v[32:33] op_sel:[0,0] op_sel_hi:[0,1]
    v_pk_fma_f32 v[64:65], v[62:63], v[32:33], v[64:65] op_sel:[1,1,0] op_sel_hi:[1,0,1] neg_lo:[0,1,0]
    v_cvt_pk_bf16_f32 v75, v64, v65
    ds_write_b32 v12, v75 offset:14960
    v_pk_mul_f32 v[66:67], v[64:65], v[32:33] op_sel:[0,0] op_sel_hi:[0,1]
    v_pk_fma_f32 v[66:67], v[64:65], v[32:33], v[66:67] op_sel:[1,1,0] op_sel_hi:[1,0,1] neg_lo:[0,1,0]
    v_cvt_pk_bf16_f32 v74, v66, v67
    ds_write_b32 v12, v74 offset:15232
    v_pk_mul_f32 v[68:69], v[30:31], v[40:41] op_sel:[0,0] op_sel_hi:[0,1]
    v_pk_mul_f32 v[70:71], v[36:37], v[40:41] op_sel:[0,0] op_sel_hi:[0,1]
    v_pk_fma_f32 v[68:69], v[30:31], v[40:41], v[68:69] op_sel:[1,1,0] op_sel_hi:[1,0,1] neg_lo:[0,1,0]
    v_pk_fma_f32 v[70:71], v[36:37], v[40:41], v[70:71] op_sel:[1,1,0] op_sel_hi:[1,0,1] neg_lo:[0,1,0]
    v_cvt_pk_bf16_f32 v72, v68, v69
    v_cvt_pk_bf16_f32 v75, v70, v71
    ds_write_b32 v12, v72 offset:8976
    ds_write_b32 v12, v75 offset:9248
    v_pk_mul_f32 v[68:69], v[38:39], v[40:41] op_sel:[0,0] op_sel_hi:[0,1]
    v_pk_mul_f32 v[70:71], v[30:31], v[42:43] op_sel:[0,0] op_sel_hi:[0,1]
    v_pk_fma_f32 v[68:69], v[38:39], v[40:41], v[68:69] op_sel:[1,1,0] op_sel_hi:[1,0,1] neg_lo:[0,1,0]
    v_pk_fma_f32 v[70:71], v[30:31], v[42:43], v[70:71] op_sel:[1,1,0] op_sel_hi:[1,0,1] neg_lo:[0,1,0]
    v_cvt_pk_bf16_f32 v73, v68, v69
    v_cvt_pk_bf16_f32 v74, v70, v71
    ds_write_b32 v12, v73 offset:9520
    ds_write_b32 v12, v74 offset:10064
    v_pk_mul_f32 v[68:69], v[36:37], v[42:43] op_sel:[0,0] op_sel_hi:[0,1]
    v_pk_mul_f32 v[70:71], v[38:39], v[42:43] op_sel:[0,0] op_sel_hi:[0,1]
    v_pk_fma_f32 v[68:69], v[36:37], v[42:43], v[68:69] op_sel:[1,1,0] op_sel_hi:[1,0,1] neg_lo:[0,1,0]
    v_pk_fma_f32 v[70:71], v[38:39], v[42:43], v[70:71] op_sel:[1,1,0] op_sel_hi:[1,0,1] neg_lo:[0,1,0]
    v_cvt_pk_bf16_f32 v72, v68, v69
    v_cvt_pk_bf16_f32 v75, v70, v71
    ds_write_b32 v12, v72 offset:10336
    ds_write_b32 v12, v75 offset:10608
    v_pk_mul_f32 v[68:69], v[36:37], v[44:45] op_sel:[0,0] op_sel_hi:[0,1]
    v_pk_mul_f32 v[70:71], v[36:37], v[46:47] op_sel:[0,0] op_sel_hi:[0,1]
    v_pk_fma_f32 v[68:69], v[36:37], v[44:45], v[68:69] op_sel:[1,1,0] op_sel_hi:[1,0,1] neg_lo:[0,1,0]
    v_pk_fma_f32 v[70:71], v[36:37], v[46:47], v[70:71] op_sel:[1,1,0] op_sel_hi:[1,0,1] neg_lo:[0,1,0]
    v_cvt_pk_bf16_f32 v73, v68, v69
    v_cvt_pk_bf16_f32 v74, v70, v71
    ds_write_b32 v12, v73 offset:11968
    ds_write_b32 v12, v74 offset:12240
    v_pk_mul_f32 v[68:69], v[36:37], v[48:49] op_sel:[0,0] op_sel_hi:[0,1]
    v_pk_mul_f32 v[70:71], v[36:37], v[50:51] op_sel:[0,0] op_sel_hi:[0,1]
    v_pk_fma_f32 v[68:69], v[36:37], v[48:49], v[68:69] op_sel:[1,1,0] op_sel_hi:[1,0,1] neg_lo:[0,1,0]
    v_pk_fma_f32 v[70:71], v[36:37], v[50:51], v[70:71] op_sel:[1,1,0] op_sel_hi:[1,0,1] neg_lo:[0,1,0]
    v_cvt_pk_bf16_f32 v72, v68, v69
    v_cvt_pk_bf16_f32 v75, v70, v71
    ds_write_b32 v12, v72 offset:12512
    ds_write_b32 v12, v75 offset:12784
    s_add_u32 m0, s52, 16384
    s_add_u32 s56, s45, 0
    buffer_load_dwordx4 v7, s[4:7], s56 offen lds
    s_add_u32 m0, s52, 20480
    s_add_u32 s56, s45, 32768
    buffer_load_dwordx4 v7, s[4:7], s56 offen lds
    s_add_u32 m0, s52, 24576
    s_add_u32 s56, s45, 65536
    buffer_load_dwordx4 v7, s[4:7], s56 offen lds
    s_add_u32 m0, s52, 28672
    s_add_u32 s56, s45, 98304
    buffer_load_dwordx4 v7, s[4:7], s56 offen lds
    s_add_u32 m0, s52, 81920
    s_nop 0
    buffer_load_dwordx4 v3, s[8:11], s37 offen lds
    s_add_u32 m0, s52, 86016
    s_nop 0
    buffer_load_dwordx4 v4, s[8:11], s37 offen lds
    s_add_u32 m0, s52, 90112
    s_nop 0
    buffer_load_dwordx4 v3, s[12:15], s37 offen lds
    s_add_u32 m0, s52, 94208
    s_nop 0
    buffer_load_dwordx4 v4, s[12:15], s37 offen lds
    s_waitcnt vmcnt(12) lgkmcnt(0)
    s_barrier
    s_setprio 1
    ds_read_b64_tr_b16 v[116:117], v10 offset:0
    ds_read_b64_tr_b16 v[118:119], v10 offset:1024
    s_add_u32 s46, s35, 2
    s_and_b32 s46, s46, 7
    s_mul_i32 s38, s46, 229376
    s_add_u32 s38, s38, s82
    s_lshl_b32 s46, s46, 7
    s_add_u32 s46, s46, s83
    s_add_u32 m0, s52, 98304
    s_nop 0
    buffer_load_dwordx4 v5, s[8:11], s37 offen lds
    s_add_u32 m0, s52, 102400
    s_nop 0
    buffer_load_dwordx4 v6, s[8:11], s37 offen lds
    s_add_u32 m0, s52, 106496
    s_nop 0
    buffer_load_dwordx4 v5, s[12:15], s37 offen lds
    s_add_u32 m0, s52, 110592
    s_nop 0
    buffer_load_dwordx4 v6, s[12:15], s37 offen lds
    s_getpc_b64 s[92:93]
PC_2:
    s_add_u32 s92, s92, L_TAB-PC_2
    s_addc_u32 s93, s93, 0
    v_and_b32 v13, 255, v0
    v_lshlrev_b32 v13, 4, v13
    global_load_dwordx4 v[200:203], v13, s[92:93]
    v_add_u32 v13, 4096, v13
    global_load_dwordx4 v[204:207], v13, s[92:93]
    v_add_u32 v13, 4096, v13
    global_load_dwordx4 v[208:211], v13, s[92:93]
    v_add_u32 v13, 4096, v13
    global_load_dwordx4 v[212:215], v13, s[92:93]
    v_add_u32 v13, 4096, v13
    global_load_dwordx4 v[216:219], v13, s[92:93]
    s_bfe_u32 s55, s32, 0x10001
    s_mul_i32 s55, s55, 3072
    s_add_u32 s55, s55, 160004
    v_mov_b32 v222, s55
    s_cmp_lg_u32 s32, 4
    s_cbranch_scc1 W0_3
    buffer_load_dword v9, off, s[24:27], 0 sc1
W0_3:
    s_waitcnt vmcnt(17) lgkmcnt(0)
    s_barrier
    ds_read_b64_tr_b16 v[120:121], v10 offset:16384
    ds_read_b64_tr_b16 v[122:123], v10 offset:17408
    ds_read_b128 v[16:19], v198 offset:0
    ds_read_b128 v[48:51], v235 offset:4352
    ds_read_b128 v[80:83], v235 offset:8704
    ds_read_b128 v[20:23], v198 offset:64
    ds_read_b128 v[52:55], v235 offset:4416
    ds_read_b128 v[84:87], v235 offset:8768
    ds_read_b128 v[24:27], v198 offset:128
    ds_read_b128 v[56:59], v235 offset:4480
    ds_read_b128 v[88:91], v235 offset:8832
    ds_read_b128 v[28:31], v198 offset:192
    ds_read_b128 v[60:63], v235 offset:4544
    ds_read_b128 v[92:95], v235 offset:8896
    s_add_u32 m0, s52, 49152
    s_nop 0
    buffer_load_dwordx4 v3, s[8:11], s38 offen lds
    s_add_u32 m0, s52, 53248
    s_nop 0
    buffer_load_dwordx4 v4, s[8:11], s38 offen lds
    s_add_u32 m0, s52, 57344
    s_nop 0
    buffer_load_dwordx4 v3, s[12:15], s38 offen lds
    s_add_u32 m0, s52, 61440
    s_nop 0
    buffer_load_dwordx4 v4, s[12:15], s38 offen lds
    v_mfma_f32_16x16x32_bf16 v[124:127], v[116:119], v[112:115], 0
    s_add_u32 s47, s35, 3
    s_and_b32 s47, s47, 7
    s_mul_i32 s39, s47, 229376
    s_add_u32 s39, s39, s82
    s_lshl_b32 s47, s47, 7
    s_add_u32 s47, s47, s83
    s_waitcnt vmcnt(13) lgkmcnt(0)
    s_barrier
    ds_read_b64_tr_b16 v[116:117], v10 offset:32768
    ds_read_b64_tr_b16 v[118:119], v10 offset:33792
    ds_read_b128 v[32:35], v199 offset:0
    ds_read_b128 v[64:67], v236 offset:4352
    ds_read_b128 v[96:99], v236 offset:8704
    ds_read_b128 v[36:39], v199 offset:64
    ds_read_b128 v[68:71], v236 offset:4416
    ds_read_b128 v[100:103], v236 offset:8768
    ds_read_b128 v[40:43], v199 offset:128
    ds_read_b128 v[72:75], v236 offset:4480
    ds_read_b128 v[104:107], v236 offset:8832
    ds_read_b128 v[44:47], v199 offset:192
    ds_read_b128 v[76:79], v236 offset:4544
    ds_read_b128 v[108:111], v236 offset:8896
    s_add_u32 m0, s52, 32768
    s_add_u32 s56, s46, 0
    buffer_load_dwordx4 v7, s[4:7], s56 offen lds
    s_add_u32 m0, s52, 36864
    s_add_u32 s56, s46, 32768
    buffer_load_dwordx4 v7, s[4:7], s56 offen lds
    s_add_u32 m0, s52, 40960
    s_add_u32 s56, s46, 65536
    buffer_load_dwordx4 v7, s[4:7], s56 offen lds
    s_add_u32 m0, s52, 45056
    s_add_u32 s56, s46, 98304
    buffer_load_dwordx4 v7, s[4:7], s56 offen lds
    s_add_u32 m0, s52, 65536
    s_nop 0
    buffer_load_dwordx4 v5, s[8:11], s38 offen lds
    s_add_u32 m0, s52, 69632
    s_nop 0
    buffer_load_dwordx4 v6, s[8:11], s38 offen lds
    s_add_u32 m0, s52, 73728
    s_nop 0
    buffer_load_dwordx4 v5, s[12:15], s38 offen lds
    s_add_u32 m0, s52, 77824
    s_nop 0
    buffer_load_dwordx4 v6, s[12:15], s38 offen lds
    s_add_u32 m0, s52, 0
    s_add_u32 s56, s47, 0
    buffer_load_dwordx4 v7, s[4:7], s56 offen lds
    s_add_u32 m0, s52, 4096
    s_add_u32 s56, s47, 32768
    buffer_load_dwordx4 v7, s[4:7], s56 offen lds
    v_mfma_f32_16x16x32_bf16 v[224:227], v[48:51], v[16:19], 0
    v_mfma_f32_16x16x32_bf16 v[228:231], v[80:83], v[16:19], 0
    v_mfma_f32_16x16x32_bf16 v[224:227], v[52:55], v[20:23], v[224:227]
    v_mfma_f32_16x16x32_bf16 v[228:231], v[84:87], v[20:23], v[228:231]
    v_mfma_f32_16x16x32_bf16 v[224:227], v[56:59], v[24:27], v[224:227]
    v_mfma_f32_16x16x32_bf16 v[228:231], v[88:91], v[24:27], v[228:231]
    v_mfma_f32_16x16x32_bf16 v[224:227], v[60:63], v[28:31], v[224:227]
    v_mfma_f32_16x16x32_bf16 v[228:231], v[92:95], v[28:31], v[228:231]
    v_mfma_f32_16x16x32_bf16 v[124:127], v[120:123], v[112:115], v[124:127]
    s_waitcnt vmcnt(19) lgkmcnt(0)
    s_barrier
    ds_read_b64_tr_b16 v[120:121], v10 offset:49152
    ds_read_b64_tr_b16 v[122:123], v10 offset:50176
    s_add_u32 m0, s52, 8192
    s_add_u32 s56, s47, 65536
    buffer_load_dwordx4 v7, s[4:7], s56 offen lds
    s_add_u32 m0, s52, 12288
    s_add_u32 s56, s47, 98304
    buffer_load_dwordx4 v7, s[4:7], s56 offen lds
    s_add_u32 m0, s52, 81920
    s_nop 0
    buffer_load_dwordx4 v3, s[8:11], s39 offen lds
    s_add_u32 m0, s52, 86016
    s_nop 0
    buffer_load_dwordx4 v4, s[8:11], s39 offen lds
    s_add_u32 m0, s52, 90112
    s_nop 0
    buffer_load_dwordx4 v3, s[12:15], s39 offen lds
    s_add_u32 m0, s52, 94208
    s_nop 0
    buffer_load_dwordx4 v4, s[12:15], s39 offen lds
    v_mfma_f32_16x16x32_bf16 v[224:227], v[64:67], v[32:35], v[224:227]
    v_mfma_f32_16x16x32_bf16 v[228:231], v[96:99], v[32:35], v[228:231]
    v_mfma_f32_16x16x32_bf16 v[224:227], v[68:71], v[36:39], v[224:227]
    v_mfma_f32_16x16x32_bf16 v[228:231], v[100:103], v[36:39], v[228:231]
    v_mfma_f32_16x16x32_bf16 v[224:227], v[72:75], v[40:43], v[224:227]
    v_mfma_f32_16x16x32_bf16 v[228:231], v[104:107], v[40:43], v[228:231]
    v_mfma_f32_16x16x32_bf16 v[224:227], v[76:79], v[44:47], v[224:227]
    v_mfma_f32_16x16x32_bf16 v[228:231], v[108:111], v[44:47], v[228:231]
    v_mfma_f32_16x16x32_bf16 v[124:127], v[116:119], v[112:115], v[124:127]
    s_add_u32 s48, s35, 4
    s_and_b32 s48, s48, 7
    s_mul_i32 s40, s48, 229376
    s_add_u32 s40, s40, s82
    s_lshl_b32 s48, s48, 7
    s_add_u32 s48, s48, s83
    s_waitcnt vmcnt(12) lgkmcnt(0)
    s_barrier
    v_mfma_f32_16x16x32_bf16 v[124:127], v[120:123], v[112:115], v[124:127]
    s_mul_i32 s71, s32, 229376
    s_lshl_b32 s53, s58, 7
    s_add_u32 s71, s71, s53
    s_lshl_b32 s72, s32, 12
    s_lshl_b32 s77, s57, 16
    s_add_u32 s77, s77, s53
    s_lshl_b32 s54, s32, 13
    s_add_u32 s77, s77, s54
    s_lshr_b32 s53, s2, 2
    s_and_b32 s53, s53, 6
    s_and_b32 s54, s2, 7
    s_add_u32 s53, s53, s54
    s_sub_u32 s54, s53, 7
    s_cmp_ge_u32 s53, 7
    s_cselect_b32 s53, s54, s53
    s_lshl_b32 s64, s53, 10
    s_lshl_b32 s55, s34, 2
    s_lshr_b32 s56, s33, 2
    s_add_u32 s55, s55, s56
    s_lshl_b32 s55, s55, 10
    s_bfe_u32 s56, s32, 0x10001
    s_lshl_b32 s56, s56, 9
    s_add_u32 s55, s55, s56
    s_and_b32 s56, s33, 3
    s_lshl_b32 s56, s56, 7
    s_add_u32 s55, s55, s56
    s_and_b32 s56, s32, 1
    s_lshl_b32 s56, s56, 6
    s_add_u32 s55, s55, s56
    s_add_u32 s55, s55, 3276800
    s_mov_b32 s60, 0x00010001
    s_mov_b32 s61, 0x00010001
    s_mov_b64 exec, s[60:61]
    buffer_store_dwordx4 v[124:127], v1, s[28:31], s55 offen sc1
    s_mov_b64 exec, -1
    s_add_u32 m0, s52, 98304
    s_nop 0
    buffer_load_dwordx4 v5, s[8:11], s39 offen lds
    s_add_u32 m0, s52, 102400
    s_nop 0
    buffer_load_dwordx4 v6, s[8:11], s39 offen lds
    s_add_u32 m0, s52, 106496
    s_nop 0
    buffer_load_dwordx4 v5, s[12:15], s39 offen lds
    s_add_u32 m0, s52, 110592
    s_nop 0
    buffer_load_dwordx4 v6, s[12:15], s39 offen lds
    s_add_u32 m0, s52, 16384
    s_add_u32 s56, s48, 0
    buffer_load_dwordx4 v7, s[4:7], s56 offen lds
    s_add_u32 m0, s52, 20480
    s_add_u32 s56, s48, 32768
    buffer_load_dwordx4 v7, s[4:7], s56 offen lds
    s_waitcnt vmcnt(15)
    s_barrier
    s_add_u32 m0, s52, 24576
    s_add_u32 s56, s48, 65536
    buffer_load_dwordx4 v7, s[4:7], s56 offen lds
    s_add_u32 m0, s52, 28672
    s_add_u32 s56, s48, 98304
    buffer_load_dwordx4 v7, s[4:7], s56 offen lds
    s_add_u32 m0, s52, 49152
    s_nop 0
    buffer_load_dwordx4 v3, s[8:11], s40 offen lds
    s_add_u32 m0, s52, 53248
    s_nop 0
    buffer_load_dwordx4 v4, s[8:11], s40 offen lds
    s_add_u32 m0, s52, 57344
    s_nop 0
    buffer_load_dwordx4 v3, s[12:15], s40 offen lds
    s_add_u32 m0, s52, 61440
    s_nop 0
    buffer_load_dwordx4 v4, s[12:15], s40 offen lds
    s_cmp_lg_u32 s32, 4
    s_cbranch_scc1 W0_4
    s_mov_b32 s62, 0
NP_5:
    v_readfirstlane_b32 s90, v9
    s_add_u32 s62, s62, 1
    s_nop 2
    s_cmp_lg_u32 s90, 0
    s_cbranch_scc1 NK_6
    s_cmp_ge_u32 s62, 0x4000
    s_cbranch_scc1 NK_6
    s_sleep 8
    buffer_load_dword v9, off, s[24:27], 0 sc1
    s_waitcnt vmcnt(0)
    s_branch NP_5
NK_6:
W0_4:
    s_add_u32 s49, s35, 5
    s_and_b32 s49, s49, 7
    s_mul_i32 s41, s49, 229376
    s_add_u32 s41, s41, s82
    s_lshl_b32 s49, s49, 7
    s_add_u32 s49, s49, s83
    s_add_u32 s53, s53, 1
    s_sub_u32 s54, s53, 7
    s_cmp_ge_u32 s53, 7
    s_cselect_b32 s53, s54, s53
    s_lshl_b32 s65, s53, 10
    s_add_u32 s53, s53, 1
    s_sub_u32 s54, s53, 7
    s_cmp_ge_u32 s53, 7
    s_cselect_b32 s53, s54, s53
    s_lshl_b32 s66, s53, 10
    s_add_u32 s53, s53, 1
    s_sub_u32 s54, s53, 7
    s_cmp_ge_u32 s53, 7
    s_cselect_b32 s53, s54, s53
    s_lshl_b32 s67, s53, 10
    s_add_u32 s53, s53, 1
    s_sub_u32 s54, s53, 7
    s_cmp_ge_u32 s53, 7
    s_cselect_b32 s53, s54, s53
    s_lshl_b32 s68, s53, 10
    s_add_u32 s53, s53, 1
    s_sub_u32 s54, s53, 7
    s_cmp_ge_u32 s53, 7
    s_cselect_b32 s53, s54, s53
    s_lshl_b32 s69, s53, 10
    s_add_u32 s53, s53, 1
    s_sub_u32 s54, s53, 7
    s_cmp_ge_u32 s53, 7
    s_cselect_b32 s53, s54, s53
    s_lshl_b32 s70, s53, 10
    s_waitcnt vmcnt(13)
    s_barrier
    s_add_u32 m0, s52, 65536
    s_nop 0
    buffer_load_dwordx4 v5, s[8:11], s40 offen lds
    s_add_u32 m0, s52, 69632
    s_nop 0
    buffer_load_dwordx4 v6, s[8:11], s40 offen lds
    s_add_u32 m0, s52, 73728
    s_nop 0
    buffer_load_dwordx4 v5, s[12:15], s40 offen lds
    s_add_u32 m0, s52, 77824
    s_nop 0
    buffer_load_dwordx4 v6, s[12:15], s40 offen lds
    s_add_u32 m0, s52, 32768
    s_add_u32 s56, s49, 0
    buffer_load_dwordx4 v7, s[4:7], s56 offen lds
    s_add_u32 m0, s52, 36864
    s_add_u32 s56, s49, 32768
    buffer_load_dwordx4 v7, s[4:7], s56 offen lds
    s_mul_i32 s53, s57, 224
    s_mul_i32 s54, s32, 7
    s_add_u32 s53, s53, s54
    s_lshl_b32 s53, s53, 10
    s_add_u32 s53, s53, 4194304
    s_add_u32 s73, s58, 0
    s_and_b32 s73, s73, 3
    s_mul_i32 s73, s73, 57344
    s_add_u32 s73, s73, s53
    s_add_u32 s74, s58, 1
    s_and_b32 s74, s74, 3
    s_mul_i32 s74, s74, 57344
    s_add_u32 s74, s74, s53
    s_add_u32 s75, s58, 2
    s_and_b32 s75, s75, 3
    s_mul_i32 s75, s75, 57344
    s_add_u32 s75, s75, s53
    s_add_u32 s76, s58, 3
    s_and_b32 s76, s76, 3
    s_mul_i32 s76, s76, 57344
    s_add_u32 s76, s76, s53
    s_waitcnt vmcnt(14)
    s_barrier
    s_add_u32 m0, s52, 40960
    s_add_u32 s56, s49, 65536
    buffer_load_dwordx4 v7, s[4:7], s56 offen lds
    s_add_u32 m0, s52, 45056
    s_add_u32 s56, s49, 98304
    buffer_load_dwordx4 v7, s[4:7], s56 offen lds
    s_add_u32 m0, s52, 81920
    s_nop 0
    buffer_load_dwordx4 v3, s[8:11], s41 offen lds
    s_add_u32 m0, s52, 86016
    s_nop 0
    buffer_load_dwordx4 v4, s[8:11], s41 offen lds
    s_add_u32 m0, s52, 90112
    s_nop 0
    buffer_load_dwordx4 v3, s[12:15], s41 offen lds
    s_add_u32 m0, s52, 94208
    s_nop 0
    buffer_load_dwordx4 v4, s[12:15], s41 offen lds
    s_cmp_lg_u32 s32, 4
    s_cbranch_scc1 W0_7
    s_mul_i32 s62, s34, 4224
    s_add_u32 s62, s62, 3513472
    s_lshl_b32 s60, s33, 7
    s_add_u32 s62, s62, s60
    v_mov_b32 v13, s90
    s_mov_b64 exec, 1
    buffer_store_dword v13, off, s[28:31], s62 sc1
    s_mov_b64 exec, -1
W0_7:
    s_add_u32 s50, s35, 6
    s_and_b32 s50, s50, 7
    s_mul_i32 s42, s50, 229376
    s_add_u32 s42, s42, s82
    s_lshl_b32 s50, s50, 7
    s_add_u32 s50, s50, s83
    s_waitcnt vmcnt(12)
    s_barrier
    s_add_u32 m0, s52, 98304
    s_nop 0
    buffer_load_dwordx4 v5, s[8:11], s41 offen lds
    s_add_u32 m0, s52, 102400
    s_nop 0
    buffer_load_dwordx4 v6, s[8:11], s41 offen lds
    s_add_u32 m0, s52, 106496
    s_nop 0
    buffer_load_dwordx4 v5, s[12:15], s41 offen lds
    s_add_u32 m0, s52, 110592
    s_nop 0
    buffer_load_dwordx4 v6, s[12:15], s41 offen lds
    s_add_u32 m0, s52, 0
    s_add_u32 s56, s50, 0
    buffer_load_dwordx4 v7, s[4:7], s56 offen lds
    s_add_u32 m0, s52, 4096
    s_add_u32 s56, s50, 32768
    buffer_load_dwordx4 v7, s[4:7], s56 offen lds
    v_lshrrev_b32 v13, 4, v1
    v_lshlrev_b32 v13, 1, v13
    v_xor_b32 v13, v13, v1
    v_and_b32 v13, 7, v13
    v_lshrrev_b32 v14, 3, v1
    v_lshlrev_b32 v244, 10, v14
    v_lshl_add_u32 v244, v13, 4, v244
    v_and_b32 v14, 3, v14
    v_lshlrev_b32 v14, 5, v14
    v_lshrrev_b32 v13, 2, v1
    v_lshl_add_u32 v14, v13, 7, v14
    v_and_b32 v249, 3, v1
    v_lshl_add_u32 v14, v249, 3, v14
    v_add_u32 v245, s72, v14
    v_xor_b32 v246, 32, v245
    v_xor_b32 v247, 64, v245
    v_xor_b32 v248, 96, v245
    v_lshl_add_u32 v13, v249, 2, v13
    v_and_b32 v13, 15, v13
    v_lshl_add_u32 v13, v249, 4, v13
    s_lshl_b32 s53, s32, 10
    s_add_u32 s53, s53, 65536
    v_lshl_add_u32 v249, v13, 4, s53
    v_lshlrev_b32 v250, 3, v0
    v_add_u32 v250, 148480, v250
    s_waitcnt vmcnt(14)
    s_barrier
    s_add_u32 m0, s52, 8192
    s_add_u32 s56, s50, 65536
    buffer_load_dwordx4 v7, s[4:7], s56 offen lds
    s_add_u32 m0, s52, 12288
    s_add_u32 s56, s50, 98304
    buffer_load_dwordx4 v7, s[4:7], s56 offen lds
    s_add_u32 m0, s52, 49152
    s_nop 0
    buffer_load_dwordx4 v3, s[8:11], s42 offen lds
    s_add_u32 m0, s52, 53248
    s_nop 0
    buffer_load_dwordx4 v4, s[8:11], s42 offen lds
    s_add_u32 m0, s52, 57344
    s_nop 0
    buffer_load_dwordx4 v3, s[12:15], s42 offen lds
    s_add_u32 m0, s52, 61440
    s_nop 0
    buffer_load_dwordx4 v4, s[12:15], s42 offen lds
    s_add_u32 s51, s35, 7
    s_and_b32 s51, s51, 7
    s_mul_i32 s43, s51, 229376
    s_add_u32 s43, s43, s82
    s_lshl_b32 s51, s51, 7
    s_add_u32 s51, s51, s83
    s_waitcnt vmcnt(12)
    s_barrier
    s_add_u32 m0, s52, 65536
    s_nop 0
    buffer_load_dwordx4 v5, s[8:11], s42 offen lds
    s_add_u32 m0, s52, 69632
    s_nop 0
    buffer_load_dwordx4 v6, s[8:11], s42 offen lds
    s_add_u32 m0, s52, 73728
    s_nop 0
    buffer_load_dwordx4 v5, s[12:15], s42 offen lds
    s_add_u32 m0, s52, 77824
    s_nop 0
    buffer_load_dwordx4 v6, s[12:15], s42 offen lds
    s_add_u32 m0, s52, 16384
    s_add_u32 s56, s51, 0
    buffer_load_dwordx4 v7, s[4:7], s56 offen lds
    s_add_u32 m0, s52, 20480
    s_add_u32 s56, s51, 32768
    buffer_load_dwordx4 v7, s[4:7], s56 offen lds
    v_and_b32 v13, 15, v1
    v_lshrrev_b32 v14, 4, v1
    v_lshl_add_u32 v192, v14, 3, v13
    s_bfe_u32 s55, s32, 0x10001
    s_mul_i32 s56, s55, 16640
    s_add_u32 s56, s56, 114688
    s_and_b32 s53, s32, 1
    s_lshl_b32 s54, s53, 5
    s_sub_u32 s54, 71, s54
    v_sub_u32 v192, s54, v192
    v_and_b32 v193, 3, v192
    v_sub_u32 v192, v192, v193
    v_lshlrev_b32 v192, 1, v192
    v_mul_u32_u24 v193, 4160, v193
    v_add3_u32 v232, v192, v193, s56
    v_lshlrev_b32 v192, 5, v13
    v_lshlrev_b32 v193, 4, v14
    v_sub_u32 v192, v192, v193
    s_mul_i32 s54, s55, 4608
    s_lshl_b32 s53, s53, 6
    s_sub_u32 s54, s54, s53
    s_add_u32 s54, s54, 148112
    v_add_u32 v233, s54, v192
    v_lshl_add_u32 v13, v14, 2, v13
    v_and_b32 v13, 15, v13
    v_lshl_add_u32 v13, v14, 4, v13
    s_lshl_b32 s53, s52, 3
    s_add_u32 s53, s53, 65536
    v_lshl_add_u32 v234, v13, 4, s53
    s_waitcnt vmcnt(14)
    s_barrier
    s_add_u32 m0, s52, 24576
    s_add_u32 s56, s51, 65536
    buffer_load_dwordx4 v7, s[4:7], s56 offen lds
    s_add_u32 m0, s52, 28672
    s_add_u32 s56, s51, 98304
    buffer_load_dwordx4 v7, s[4:7], s56 offen lds
    s_add_u32 m0, s52, 81920
    s_nop 0
    buffer_load_dwordx4 v3, s[8:11], s43 offen lds
    s_add_u32 m0, s52, 86016
    s_nop 0
    buffer_load_dwordx4 v4, s[8:11], s43 offen lds
    s_add_u32 m0, s52, 90112
    s_nop 0
    buffer_load_dwordx4 v3, s[12:15], s43 offen lds
    s_add_u32 m0, s52, 94208
    s_nop 0
    buffer_load_dwordx4 v4, s[12:15], s43 offen lds
    s_cmp_lg_u32 s32, 4
    s_cbranch_scc1 W0_8
    s_mul_i32 s87, s34, 4224
    s_add_u32 s87, s87, 3513472
    v_lshlrev_b32 v9, 7, v1
    s_mov_b64 exec, 0xffff
    buffer_load_dword v9, v9, s[28:31], s87 offen sc1
    s_mov_b64 exec, -1
W0_8:
    s_cmp_lg_u32 s32, 4
    s_cbranch_scc1 W0_9
    s_mov_b32 s91, 3407872
    v_lshlrev_b32 v8, 7, v1
    s_mov_b64 exec, 0xffffffff
    buffer_load_dword v8, v8, s[28:31], s91 offen sc1
    s_mov_b64 exec, -1
W0_9:
    s_waitcnt vmcnt(12)
    s_barrier
    s_add_u32 m0, s52, 98304
    s_nop 0
    buffer_load_dwordx4 v5, s[8:11], s43 offen lds
    s_add_u32 m0, s52, 102400
    s_nop 0
    buffer_load_dwordx4 v6, s[8:11], s43 offen lds
    s_add_u32 m0, s52, 106496
    s_nop 0
    buffer_load_dwordx4 v5, s[12:15], s43 offen lds
    s_add_u32 m0, s52, 110592
    s_nop 0
    buffer_load_dwordx4 v6, s[12:15], s43 offen lds
    s_cmp_lg_u32 s32, 4
    s_cbranch_scc1 W0_11
    s_waitcnt vmcnt(5)
    s_mov_b32 s62, 0
POLL_10:
    v_cmp_ne_u32 vcc, s90, v9
    s_add_u32 s62, s62, 1
    s_and_b32 s60, vcc_lo, 0xffff
    s_cbranch_scc0 W0_11
    s_cmp_ge_u32 s62, 0x4000
    s_cbranch_scc1 W0_11
    s_sleep 2
    v_lshlrev_b32 v9, 7, v1
    s_mov_b64 exec, 0xffff
    buffer_load_dword v9, v9, s[28:31], s87 offen sc1
    s_mov_b64 exec, -1
    s_waitcnt vmcnt(0)
    s_branch POLL_10
W0_11:
    s_cmp_lg_u32 s32, 4
    s_cbranch_scc1 W0_13
    s_waitcnt vmcnt(4)
    s_mov_b32 s62, 0
POLL_12:
    v_cmp_ne_u32 vcc, s90, v8
    s_add_u32 s62, s62, 1
    s_and_b32 s60, vcc_lo, 0xffffffff
    s_cbranch_scc0 W0_13
    s_cmp_ge_u32 s62, 0x4000
    s_cbranch_scc1 W0_13
    s_sleep 2
    v_lshlrev_b32 v8, 7, v1
    s_mov_b64 exec, 0xffffffff
    buffer_load_dword v8, v8, s[28:31], s91 offen sc1
    s_mov_b64 exec, -1
    s_waitcnt vmcnt(0)
    s_branch POLL_12
W0_13:
    s_waitcnt vmcnt(12)
    s_barrier
    v_lshlrev_b32 v10, 4, v1
    s_cmp_ge_u32 s32, 6
    s_cbranch_scc1 SC_14
    s_lshl_b32 s55, s33, 11
    s_add_u32 s55, s55, s52
    s_add_u32 s55, s55, 3145728
    buffer_load_dwordx4 v[80:83], v10, s[28:31], s55 offen sc1
    s_branch SC_15
SC_14:
    s_lshl_b32 s55, s34, 12
    s_add_u32 s55, s55, 3276800
    buffer_load_dwordx4 v[80:83], v10, s[28:31], s55 offen offset:0 sc1
    buffer_load_dwordx4 v[84:87], v10, s[28:31], s55 offen offset:1024 sc1
    buffer_load_dwordx4 v[88:91], v10, s[28:31], s55 offen offset:2048 sc1
    buffer_load_dwordx4 v[92:95], v10, s[28:31], s55 offen offset:3072 sc1
SC_15:
    v_bfe_u32 v13, v0, 4, 4
    v_mul_u32_u24 v13, 65792, v13
    v_and_b32 v14, 15, v0
    v_lshl_add_u32 v13, v14, 4, v13
    s_lshl_b32 s54, s2, 8
    s_add_u32 s55, s54, 1052672
    buffer_load_dwordx4 v[72:75], v13, s[28:31], s54 offen sc1
    buffer_load_dwordx4 v[76:79], v13, s[28:31], s55 offen sc1
    v_mov_b32 v13, 0
    ds_write_b16 v222, v13
    v_cvt_pk_bf16_f32 v224, v224, v224
    v_cvt_pk_bf16_f32 v225, v225, v225
    v_cvt_pk_bf16_f32 v226, v226, v226
    v_cvt_pk_bf16_f32 v227, v227, v227
    v_cvt_pk_bf16_f32 v228, v228, v228
    v_cvt_pk_bf16_f32 v229, v229, v229
    v_cvt_pk_bf16_f32 v230, v230, v230
    v_cvt_pk_bf16_f32 v231, v231, v231
    ds_write_b16 v200, v224
    ds_write_b16 v201, v225
    ds_write_b16 v202, v226
    ds_write_b16 v203, v227
    ds_write_b16 v204, v228
    ds_write_b16 v205, v229
    ds_write_b16 v206, v230
    ds_write_b16 v207, v231
    s_waitcnt vmcnt(6) lgkmcnt(0)
    s_barrier
    ds_read_u16 v16, v208 offset:0
    ds_read_u16 v17, v209 offset:0
    ds_read_u16 v18, v210 offset:0
    ds_read_u16 v19, v211 offset:0
    ds_read_u16 v20, v212 offset:0
    ds_read_u16 v21, v213 offset:0
    ds_read_u16 v22, v214 offset:0
    ds_read_u16 v23, v215 offset:0
    ds_read_u16 v24, v216 offset:0
    ds_read_u16 v25, v217 offset:0
    ds_read_u16 v26, v218 offset:0
    ds_read_u16 v28, v208 offset:3072
    ds_read_u16 v29, v209 offset:3072
    ds_read_u16 v30, v210 offset:3072
    ds_read_u16 v31, v211 offset:3072
    ds_read_u16 v32, v212 offset:3072
    ds_read_u16 v33, v213 offset:3072
    ds_read_u16 v34, v214 offset:3072
    ds_read_u16 v35, v215 offset:3072
    ds_read_u16 v36, v216 offset:3072
    ds_read_u16 v37, v217 offset:3072
    ds_read_u16 v38, v218 offset:3072
    s_cmp_lt_u32 s32, 6
    s_cbranch_scc1 Z_17
    v_mov_b32 v192, 0
    v_mov_b32 v193, 0
    v_mov_b32 v194, 0
    v_mov_b32 v195, 0
    v_lshrrev_b32 v13, 5, v1
    v_lshlrev_b32 v13, 12, v13
    v_lshl_add_u32 v13, v1, 4, v13
    v_add_u32 v13, 147968, v13
    s_cmp_eq_u32 s32, 6
    s_cbranch_scc1 Z_16
    v_bfe_u32 v13, v1, 1, 3
    v_mul_u32_u24 v13, 4160, v13
    v_and_b32 v14, 1, v1
    v_lshl_add_u32 v13, v14, 4, v13
    v_add_u32 v13, 118784, v13
Z_16:
    ds_write_b128 v13, v[192:195]
Z_17:
    s_cmp_lg_u32 s32, 4
    s_cbranch_scc1 W0_18
    v_mov_b32 v13, 163328
    v_mov_b32 v14, s90
    ds_write_b32 v13, v14
W0_18:
    s_waitcnt lgkmcnt(0)
    v_lshl_or_b32 v40, v17, 16, v16
    v_lshl_or_b32 v41, v19, 16, v18
    v_lshl_or_b32 v42, v21, 16, v20
    v_lshl_or_b32 v43, v23, 16, v22
    v_lshl_or_b32 v44, v18, 16, v17
    v_lshl_or_b32 v45, v20, 16, v19
    v_lshl_or_b32 v46, v22, 16, v21
    v_lshl_or_b32 v47, v24, 16, v23
    v_lshl_or_b32 v48, v19, 16, v18
    v_lshl_or_b32 v49, v21, 16, v20
    v_lshl_or_b32 v50, v23, 16, v22
    v_lshl_or_b32 v51, v25, 16, v24
    v_lshl_or_b32 v52, v20, 16, v19
    v_lshl_or_b32 v53, v22, 16, v21
    v_lshl_or_b32 v54, v24, 16, v23
    v_lshl_or_b32 v55, v26, 16, v25
    v_lshl_or_b32 v56, v29, 16, v28
    v_lshl_or_b32 v57, v31, 16, v30
    v_lshl_or_b32 v58, v33, 16, v32
    v_lshl_or_b32 v59, v35, 16, v34
    v_lshl_or_b32 v60, v30, 16, v29
    v_lshl_or_b32 v61, v32, 16, v31
    v_lshl_or_b32 v62, v34, 16, v33
    v_lshl_or_b32 v63, v36, 16, v35
    v_lshl_or_b32 v64, v31, 16, v30
    v_lshl_or_b32 v65, v33, 16, v32
    v_lshl_or_b32 v66, v35, 16, v34
    v_lshl_or_b32 v67, v37, 16, v36
    v_lshl_or_b32 v68, v32, 16, v31
    v_lshl_or_b32 v69, v34, 16, v33
    v_lshl_or_b32 v70, v36, 16, v35
    v_lshl_or_b32 v71, v38, 16, v37
    s_waitcnt vmcnt(2) lgkmcnt(0)
    s_barrier
    ds_write_b128 v219, v[40:43] offset:0
    ds_write_b128 v219, v[44:47] offset:4160
    ds_write_b128 v219, v[48:51] offset:8320
    ds_write_b128 v219, v[52:55] offset:12480
    ds_write_b128 v219, v[56:59] offset:16640
    ds_write_b128 v219, v[60:63] offset:20800
    ds_write_b128 v219, v[64:67] offset:24960
    ds_write_b128 v219, v[68:71] offset:29120
    v_bfe_u32 v13, v0, 4, 4
    v_lshlrev_b32 v13, 7, v13
    v_and_b32 v14, 7, v0
    v_lshl_add_u32 v13, v14, 4, v13
    v_bfe_u32 v14, v0, 3, 1
    v_mul_u32_u24 v14, 4608, v14
    v_add_u32 v13, v13, v14
    v_add_u32 v13, 148480, v13
    s_waitcnt vmcnt(0)
    ds_write_b128 v13, v[72:75]
    ds_write_b128 v13, v[76:79] offset:2048
    s_cmp_lt_u32 s32, 6
    s_cbranch_scc1 SC_19
    v_add_f32 v80, v80, v84
    v_add_f32 v88, v88, v92
    v_add_f32 v81, v81, v85
    v_add_f32 v89, v89, v93
    v_add_f32 v82, v82, v86
    v_add_f32 v90, v90, v94
    v_add_f32 v83, v83, v87
    v_add_f32 v91, v91, v95
    v_add_f32 v80, v80, v88
    v_add_f32 v81, v81, v89
    v_add_f32 v82, v82, v90
    v_add_f32 v83, v83, v91
SC_19:
    s_min_u32 s55, s52, 2048
    s_add_u32 s55, s55, 157184
    v_add_u32 v10, s55, v10
    ds_write_b128 v10, v[80:83]
    s_waitcnt lgkmcnt(0)
    s_barrier
    s_setprio 0
L_ACONV:
    ds_read_b64 v[176:177], v232 offset:3968
    ds_read_b64 v[178:179], v232 offset:3976
    ds_read_b128 v[28:31], v233 offset:384
    ds_read_b128 v[44:47], v233 offset:896
    ds_read_b128 v[60:63], v233 offset:1408
    ds_read_b128 v[76:79], v233 offset:1920
    ds_read_b128 v[92:95], v233 offset:2432
    ds_read_b128 v[108:111], v233 offset:2944
    ds_read_b128 v[124:127], v233 offset:3456
    ds_read_b128 v[140:143], v233 offset:3968
    ds_read_b64 v[180:181], v232 offset:3840
    ds_read_b64 v[182:183], v232 offset:3848
    ds_read_b64 v[184:185], v232 offset:3712
    ds_read_b64 v[186:187], v232 offset:3720
    s_waitcnt lgkmcnt(11)
    v_mfma_f32_16x16x32_bf16 v[144:147], v[176:179], v[28:31], 0
    ds_read_b128 v[24:27], v233 offset:256
    ds_read_b64 v[188:189], v232 offset:3584
    ds_read_b64 v[190:191], v232 offset:3592
    s_waitcnt lgkmcnt(13)
    v_mfma_f32_16x16x32_bf16 v[148:151], v[176:179], v[44:47], 0
    ds_read_b128 v[40:43], v233 offset:768
    s_waitcnt lgkmcnt(13)
    v_mfma_f32_16x16x32_bf16 v[152:155], v[176:179], v[60:63], 0
    ds_read_b128 v[56:59], v233 offset:1280
    s_waitcnt lgkmcnt(13)
    v_mfma_f32_16x16x32_bf16 v[156:159], v[176:179], v[76:79], 0
    ds_read_b128 v[72:75], v233 offset:1792
    s_waitcnt lgkmcnt(13)
    v_mfma_f32_16x16x32_bf16 v[160:163], v[176:179], v[92:95], 0
    ds_read_b128 v[88:91], v233 offset:2304
    s_waitcnt lgkmcnt(13)
    v_mfma_f32_16x16x32_bf16 v[164:167], v[176:179], v[108:111], 0
    ds_read_b128 v[104:107], v233 offset:2816
    s_waitcnt lgkmcnt(13)
    v_mfma_f32_16x16x32_bf16 v[168:171], v[176:179], v[124:127], 0
    ds_read_b128 v[120:123], v233 offset:3328
    s_waitcnt lgkmcnt(13)
    v_mfma_f32_16x16x32_bf16 v[172:175], v[176:179], v[140:143], 0
    ds_read_b128 v[136:139], v233 offset:3840
    s_waitcnt lgkmcnt(9)
    v_mfma_f32_16x16x32_bf16 v[144:147], v[180:183], v[24:27], v[144:147]
    ds_read_b128 v[20:23], v233 offset:128
    ds_read_b64 v[176:177], v232 offset:3456
    ds_read_b64 v[178:179], v232 offset:3464
    s_waitcnt lgkmcnt(9)
    v_mfma_f32_16x16x32_bf16 v[148:151], v[180:183], v[40:43], v[148:151]
    ds_read_b128 v[36:39], v233 offset:640
    s_waitcnt lgkmcnt(9)
    v_mfma_f32_16x16x32_bf16 v[152:155], v[180:183], v[56:59], v[152:155]
    ds_read_b128 v[52:55], v233 offset:1152
    s_waitcnt lgkmcnt(9)
    v_mfma_f32_16x16x32_bf16 v[156:159], v[180:183], v[72:75], v[156:159]
    ds_read_b128 v[68:71], v233 offset:1664
    s_waitcnt lgkmcnt(9)
    v_mfma_f32_16x16x32_bf16 v[160:163], v[180:183], v[88:91], v[160:163]
    ds_read_b128 v[84:87], v233 offset:2176
    s_waitcnt lgkmcnt(9)
    v_mfma_f32_16x16x32_bf16 v[164:167], v[180:183], v[104:107], v[164:167]
    ds_read_b128 v[100:103], v233 offset:2688
    s_waitcnt lgkmcnt(9)
    v_mfma_f32_16x16x32_bf16 v[168:171], v[180:183], v[120:123], v[168:171]
    ds_read_b128 v[116:119], v233 offset:3200
    s_waitcnt lgkmcnt(9)
    v_mfma_f32_16x16x32_bf16 v[172:175], v[180:183], v[136:139], v[172:175]
    ds_read_b128 v[132:135], v233 offset:3712
    s_lshl_b32 s94, s64, 5
    s_add_u32 s94, s94, s71
    s_sub_u32 s94, s94, 917504
    s_sub_u32 m0, s72, 16384
    s_add_u32 s94, s94, 0
    buffer_load_dwordx4 v244, s[16:19], s94 offen lds
    s_sub_u32 m0, s72, 15360
    s_add_u32 s94, s94, 8192
    buffer_load_dwordx4 v244, s[16:19], s94 offen lds
    s_sub_u32 m0, s72, 14336
    s_add_u32 s94, s94, 8192
    buffer_load_dwordx4 v244, s[16:19], s94 offen lds
    s_sub_u32 m0, s72, 13312
    s_add_u32 s94, s94, 8192
    buffer_load_dwordx4 v244, s[16:19], s94 offen lds
    s_waitcnt lgkmcnt(9)
    v_mfma_f32_16x16x32_bf16 v[144:147], v[184:187], v[20:23], v[144:147]
    ds_read_b128 v[16:19], v233 offset:0
    ds_read_b64 v[180:181], v232 offset:3328
    ds_read_b64 v[182:183], v232 offset:3336
    s_waitcnt lgkmcnt(9)
    v_mfma_f32_16x16x32_bf16 v[148:151], v[184:187], v[36:39], v[148:151]
    ds_read_b128 v[32:35], v233 offset:512
    s_waitcnt lgkmcnt(9)
    v_mfma_f32_16x16x32_bf16 v[152:155], v[184:187], v[52:55], v[152:155]
    ds_read_b128 v[48:51], v233 offset:1024
    s_waitcnt lgkmcnt(9)
    v_mfma_f32_16x16x32_bf16 v[156:159], v[184:187], v[68:71], v[156:159]
    ds_read_b128 v[64:67], v233 offset:1536
    s_waitcnt lgkmcnt(9)
    v_mfma_f32_16x16x32_bf16 v[160:163], v[184:187], v[84:87], v[160:163]
    ds_read_b128 v[80:83], v233 offset:2048
    s_waitcnt lgkmcnt(9)
    v_mfma_f32_16x16x32_bf16 v[164:167], v[184:187], v[100:103], v[164:167]
    ds_read_b128 v[96:99], v233 offset:2560
    s_waitcnt lgkmcnt(9)
    v_mfma_f32_16x16x32_bf16 v[168:171], v[184:187], v[116:119], v[168:171]
    ds_read_b128 v[112:115], v233 offset:3072
    s_waitcnt lgkmcnt(9)
    v_mfma_f32_16x16x32_bf16 v[172:175], v[184:187], v[132:135], v[172:175]
    ds_read_b128 v[128:131], v233 offset:3584
    s_waitcnt lgkmcnt(9)
    v_mfma_f32_16x16x32_bf16 v[144:147], v[188:191], v[16:19], v[144:147]
    ds_read_b64 v[184:185], v232 offset:3200
    ds_read_b64 v[186:187], v232 offset:3208
    s_waitcnt lgkmcnt(8)
    v_mfma_f32_16x16x32_bf16 v[148:151], v[188:191], v[32:35], v[148:151]
    s_waitcnt lgkmcnt(7)
    v_mfma_f32_16x16x32_bf16 v[152:155], v[188:191], v[48:51], v[152:155]
    s_waitcnt lgkmcnt(6)
    v_mfma_f32_16x16x32_bf16 v[156:159], v[188:191], v[64:67], v[156:159]
    s_waitcnt lgkmcnt(5)
    v_mfma_f32_16x16x32_bf16 v[160:163], v[188:191], v[80:83], v[160:163]
    s_waitcnt lgkmcnt(4)
    v_mfma_f32_16x16x32_bf16 v[164:167], v[188:191], v[96:99], v[164:167]
    s_waitcnt lgkmcnt(3)
    v_mfma_f32_16x16x32_bf16 v[168:171], v[188:191], v[112:115], v[168:171]
    s_waitcnt lgkmcnt(2)
    v_mfma_f32_16x16x32_bf16 v[172:175], v[188:191], v[128:131], v[172:175]
    s_lshl_b32 s94, s64, 5
    s_add_u32 s94, s94, s71
    s_add_u32 m0, s72, 0
    s_add_u32 s94, s94, 0
    buffer_load_dwordx4 v244, s[16:19], s94 offen lds
    s_add_u32 m0, s72, 1024
    s_add_u32 s94, s94, 8192
    buffer_load_dwordx4 v244, s[16:19], s94 offen lds
    s_add_u32 m0, s72, 2048
    s_add_u32 s94, s94, 8192
    buffer_load_dwordx4 v244, s[16:19], s94 offen lds
    s_add_u32 m0, s72, 3072
    s_add_u32 s94, s94, 8192
    buffer_load_dwordx4 v244, s[16:19], s94 offen lds
    v_mfma_f32_16x16x32_bf16 v[148:151], v[176:179], v[28:31], v[148:151]
    ds_read_b64 v[188:189], v232 offset:3072
    ds_read_b64 v[190:191], v232 offset:3080
    v_mfma_f32_16x16x32_bf16 v[152:155], v[176:179], v[44:47], v[152:155]
    v_mfma_f32_16x16x32_bf16 v[156:159], v[176:179], v[60:63], v[156:159]
    v_mfma_f32_16x16x32_bf16 v[160:163], v[176:179], v[76:79], v[160:163]
    v_mfma_f32_16x16x32_bf16 v[164:167], v[176:179], v[92:95], v[164:167]
    v_mfma_f32_16x16x32_bf16 v[168:171], v[176:179], v[108:111], v[168:171]
    v_mfma_f32_16x16x32_bf16 v[172:175], v[176:179], v[124:127], v[172:175]
    v_mfma_f32_16x16x32_bf16 v[148:151], v[180:183], v[24:27], v[148:151]
    ds_read_b64 v[176:177], v232 offset:2944
    ds_read_b64 v[178:179], v232 offset:2952
    v_mfma_f32_16x16x32_bf16 v[152:155], v[180:183], v[40:43], v[152:155]
    v_mfma_f32_16x16x32_bf16 v[156:159], v[180:183], v[56:59], v[156:159]
    v_mfma_f32_16x16x32_bf16 v[160:163], v[180:183], v[72:75], v[160:163]
    v_mfma_f32_16x16x32_bf16 v[164:167], v[180:183], v[88:91], v[164:167]
    v_mfma_f32_16x16x32_bf16 v[168:171], v[180:183], v[104:107], v[168:171]
    v_mfma_f32_16x16x32_bf16 v[172:175], v[180:183], v[120:123], v[172:175]
    s_lshl_b32 s94, s65, 5
    s_add_u32 s94, s94, s71
    s_sub_u32 s94, s94, 917504
    s_add_u32 m0, s72, 16384
    s_add_u32 s94, s94, 0
    buffer_load_dwordx4 v244, s[16:19], s94 offen lds
    s_add_u32 m0, s72, 17408
    s_add_u32 s94, s94, 8192
    buffer_load_dwordx4 v244, s[16:19], s94 offen lds
    s_add_u32 m0, s72, 18432
    s_add_u32 s94, s94, 8192
    buffer_load_dwordx4 v244, s[16:19], s94 offen lds
    s_add_u32 m0, s72, 19456
    s_add_u32 s94, s94, 8192
    buffer_load_dwordx4 v244, s[16:19], s94 offen lds
    s_waitcnt lgkmcnt(4)
    v_mfma_f32_16x16x32_bf16 v[148:151], v[184:187], v[20:23], v[148:151]
    ds_read_b64 v[180:181], v232 offset:2816
    ds_read_b64 v[182:183], v232 offset:2824
    v_mfma_f32_16x16x32_bf16 v[152:155], v[184:187], v[36:39], v[152:155]
    v_mfma_f32_16x16x32_bf16 v[156:159], v[184:187], v[52:55], v[156:159]
    v_mfma_f32_16x16x32_bf16 v[160:163], v[184:187], v[68:71], v[160:163]
    v_mfma_f32_16x16x32_bf16 v[164:167], v[184:187], v[84:87], v[164:167]
    v_mfma_f32_16x16x32_bf16 v[168:171], v[184:187], v[100:103], v[168:171]
    v_mfma_f32_16x16x32_bf16 v[172:175], v[184:187], v[116:119], v[172:175]
    s_waitcnt lgkmcnt(4)
    v_mfma_f32_16x16x32_bf16 v[148:151], v[188:191], v[16:19], v[148:151]
    ds_read_b64 v[184:185], v232 offset:2688
    ds_read_b64 v[186:187], v232 offset:2696
    v_mfma_f32_16x16x32_bf16 v[152:155], v[188:191], v[32:35], v[152:155]
    v_mfma_f32_16x16x32_bf16 v[156:159], v[188:191], v[48:51], v[156:159]
    v_mfma_f32_16x16x32_bf16 v[160:163], v[188:191], v[64:67], v[160:163]
    v_mfma_f32_16x16x32_bf16 v[164:167], v[188:191], v[80:83], v[164:167]
    v_mfma_f32_16x16x32_bf16 v[168:171], v[188:191], v[96:99], v[168:171]
    v_mfma_f32_16x16x32_bf16 v[172:175], v[188:191], v[112:115], v[172:175]
    s_lshl_b32 s94, s65, 5
    s_add_u32 s94, s94, s71
    s_add_u32 m0, s72, 32768
    s_add_u32 s94, s94, 0
    buffer_load_dwordx4 v244, s[16:19], s94 offen lds
    s_add_u32 m0, s72, 33792
    s_add_u32 s94, s94, 8192
    buffer_load_dwordx4 v244, s[16:19], s94 offen lds
    s_add_u32 m0, s72, 34816
    s_add_u32 s94, s94, 8192
    buffer_load_dwordx4 v244, s[16:19], s94 offen lds
    s_add_u32 m0, s72, 35840
    s_add_u32 s94, s94, 8192
    buffer_load_dwordx4 v244, s[16:19], s94 offen lds
    s_waitcnt lgkmcnt(4)
    v_mfma_f32_16x16x32_bf16 v[152:155], v[176:179], v[28:31], v[152:155]
    ds_read_b64 v[188:189], v232 offset:2560
    ds_read_b64 v[190:191], v232 offset:2568
    v_mfma_f32_16x16x32_bf16 v[156:159], v[176:179], v[44:47], v[156:159]
    v_mfma_f32_16x16x32_bf16 v[160:163], v[176:179], v[60:63], v[160:163]
    v_mfma_f32_16x16x32_bf16 v[164:167], v[176:179], v[76:79], v[164:167]
    v_mfma_f32_16x16x32_bf16 v[168:171], v[176:179], v[92:95], v[168:171]
    v_mfma_f32_16x16x32_bf16 v[172:175], v[176:179], v[108:111], v[172:175]
    s_waitcnt lgkmcnt(4)
    v_mfma_f32_16x16x32_bf16 v[152:155], v[180:183], v[24:27], v[152:155]
    ds_read_b64 v[176:177], v232 offset:2432
    ds_read_b64 v[178:179], v232 offset:2440
    v_mfma_f32_16x16x32_bf16 v[156:159], v[180:183], v[40:43], v[156:159]
    v_mfma_f32_16x16x32_bf16 v[160:163], v[180:183], v[56:59], v[160:163]
    v_mfma_f32_16x16x32_bf16 v[164:167], v[180:183], v[72:75], v[164:167]
    v_mfma_f32_16x16x32_bf16 v[168:171], v[180:183], v[88:91], v[168:171]
    v_mfma_f32_16x16x32_bf16 v[172:175], v[180:183], v[104:107], v[172:175]
    s_waitcnt lgkmcnt(4)
    v_mfma_f32_16x16x32_bf16 v[152:155], v[184:187], v[20:23], v[152:155]
    ds_read_b64 v[180:181], v232 offset:2304
    ds_read_b64 v[182:183], v232 offset:2312
    v_mfma_f32_16x16x32_bf16 v[156:159], v[184:187], v[36:39], v[156:159]
    v_mfma_f32_16x16x32_bf16 v[160:163], v[184:187], v[52:55], v[160:163]
    v_mfma_f32_16x16x32_bf16 v[164:167], v[184:187], v[68:71], v[164:167]
    v_mfma_f32_16x16x32_bf16 v[168:171], v[184:187], v[84:87], v[168:171]
    v_mfma_f32_16x16x32_bf16 v[172:175], v[184:187], v[100:103], v[172:175]
    s_waitcnt lgkmcnt(4)
    v_mfma_f32_16x16x32_bf16 v[152:155], v[188:191], v[16:19], v[152:155]
    ds_read_b64 v[184:185], v232 offset:2176
    ds_read_b64 v[186:187], v232 offset:2184
    v_mfma_f32_16x16x32_bf16 v[156:159], v[188:191], v[32:35], v[156:159]
    v_mfma_f32_16x16x32_bf16 v[160:163], v[188:191], v[48:51], v[160:163]
    v_mfma_f32_16x16x32_bf16 v[164:167], v[188:191], v[64:67], v[164:167]
    v_mfma_f32_16x16x32_bf16 v[168:171], v[188:191], v[80:83], v[168:171]
    v_mfma_f32_16x16x32_bf16 v[172:175], v[188:191], v[96:99], v[172:175]
    s_waitcnt lgkmcnt(4)
    v_mfma_f32_16x16x32_bf16 v[156:159], v[176:179], v[28:31], v[156:159]
    ds_read_b64 v[188:189], v232 offset:2048
    ds_read_b64 v[190:191], v232 offset:2056
    v_mfma_f32_16x16x32_bf16 v[160:163], v[176:179], v[44:47], v[160:163]
    v_mfma_f32_16x16x32_bf16 v[164:167], v[176:179], v[60:63], v[164:167]
    v_mfma_f32_16x16x32_bf16 v[168:171], v[176:179], v[76:79], v[168:171]
    v_mfma_f32_16x16x32_bf16 v[172:175], v[176:179], v[92:95], v[172:175]
    s_waitcnt lgkmcnt(4)
    v_mfma_f32_16x16x32_bf16 v[156:159], v[180:183], v[24:27], v[156:159]
    ds_read_b64 v[176:177], v232 offset:1920
    ds_read_b64 v[178:179], v232 offset:1928
    v_mfma_f32_16x16x32_bf16 v[160:163], v[180:183], v[40:43], v[160:163]
    v_mfma_f32_16x16x32_bf16 v[164:167], v[180:183], v[56:59], v[164:167]
    v_mfma_f32_16x16x32_bf16 v[168:171], v[180:183], v[72:75], v[168:171]
    v_mfma_f32_16x16x32_bf16 v[172:175], v[180:183], v[88:91], v[172:175]
    s_waitcnt lgkmcnt(4)
    v_mfma_f32_16x16x32_bf16 v[156:159], v[184:187], v[20:23], v[156:159]
    ds_read_b64 v[180:181], v232 offset:1792
    ds_read_b64 v[182:183], v232 offset:1800
    v_mfma_f32_16x16x32_bf16 v[160:163], v[184:187], v[36:39], v[160:163]
    v_mfma_f32_16x16x32_bf16 v[164:167], v[184:187], v[52:55], v[164:167]
    v_mfma_f32_16x16x32_bf16 v[168:171], v[184:187], v[68:71], v[168:171]
    v_mfma_f32_16x16x32_bf16 v[172:175], v[184:187], v[84:87], v[172:175]
    s_waitcnt lgkmcnt(4)
    v_mfma_f32_16x16x32_bf16 v[156:159], v[188:191], v[16:19], v[156:159]
    ds_read_b64 v[184:185], v232 offset:1664
    ds_read_b64 v[186:187], v232 offset:1672
    v_mfma_f32_16x16x32_bf16 v[160:163], v[188:191], v[32:35], v[160:163]
    v_mfma_f32_16x16x32_bf16 v[164:167], v[188:191], v[48:51], v[164:167]
    v_mfma_f32_16x16x32_bf16 v[168:171], v[188:191], v[64:67], v[168:171]
    v_mfma_f32_16x16x32_bf16 v[172:175], v[188:191], v[80:83], v[172:175]
    s_waitcnt lgkmcnt(4)
    v_mfma_f32_16x16x32_bf16 v[160:163], v[176:179], v[28:31], v[160:163]
    ds_read_b64 v[188:189], v232 offset:1536
    ds_read_b64 v[190:191], v232 offset:1544
    v_mfma_f32_16x16x32_bf16 v[164:167], v[176:179], v[44:47], v[164:167]
    v_mfma_f32_16x16x32_bf16 v[168:171], v[176:179], v[60:63], v[168:171]
    v_mfma_f32_16x16x32_bf16 v[172:175], v[176:179], v[76:79], v[172:175]
    s_waitcnt lgkmcnt(4)
    v_mfma_f32_16x16x32_bf16 v[160:163], v[180:183], v[24:27], v[160:163]
    ds_read_b64 v[176:177], v232 offset:1408
    ds_read_b64 v[178:179], v232 offset:1416
    v_mfma_f32_16x16x32_bf16 v[164:167], v[180:183], v[40:43], v[164:167]
    v_mfma_f32_16x16x32_bf16 v[168:171], v[180:183], v[56:59], v[168:171]
    v_mfma_f32_16x16x32_bf16 v[172:175], v[180:183], v[72:75], v[172:175]
    s_waitcnt lgkmcnt(4)
    v_mfma_f32_16x16x32_bf16 v[160:163], v[184:187], v[20:23], v[160:163]
    ds_read_b64 v[180:181], v232 offset:1280
    ds_read_b64 v[182:183], v232 offset:1288
    v_mfma_f32_16x16x32_bf16 v[164:167], v[184:187], v[36:39], v[164:167]
    v_mfma_f32_16x16x32_bf16 v[168:171], v[184:187], v[52:55], v[168:171]
    v_mfma_f32_16x16x32_bf16 v[172:175], v[184:187], v[68:71], v[172:175]
    s_waitcnt lgkmcnt(4)
    v_mfma_f32_16x16x32_bf16 v[160:163], v[188:191], v[16:19], v[160:163]
    ds_read_b64 v[184:185], v232 offset:1152
    ds_read_b64 v[186:187], v232 offset:1160
    v_mfma_f32_16x16x32_bf16 v[164:167], v[188:191], v[32:35], v[164:167]
    v_mfma_f32_16x16x32_bf16 v[168:171], v[188:191], v[48:51], v[168:171]
    v_mfma_f32_16x16x32_bf16 v[172:175], v[188:191], v[64:67], v[172:175]
    s_waitcnt lgkmcnt(4)
    v_mfma_f32_16x16x32_bf16 v[164:167], v[176:179], v[28:31], v[164:167]
    ds_read_b64 v[188:189], v232 offset:1024
    ds_read_b64 v[190:191], v232 offset:1032
    v_mfma_f32_16x16x32_bf16 v[168:171], v[176:179], v[44:47], v[168:171]
    v_mfma_f32_16x16x32_bf16 v[172:175], v[176:179], v[60:63], v[172:175]
    s_waitcnt lgkmcnt(4)
    v_mfma_f32_16x16x32_bf16 v[164:167], v[180:183], v[24:27], v[164:167]
    ds_read_b64 v[176:177], v232 offset:896
    ds_read_b64 v[178:179], v232 offset:904
    v_mfma_f32_16x16x32_bf16 v[168:171], v[180:183], v[40:43], v[168:171]
    v_mfma_f32_16x16x32_bf16 v[172:175], v[180:183], v[56:59], v[172:175]
    s_waitcnt lgkmcnt(4)
    v_mfma_f32_16x16x32_bf16 v[164:167], v[184:187], v[20:23], v[164:167]
    ds_read_b64 v[180:181], v232 offset:768
    ds_read_b64 v[182:183], v232 offset:776
    v_mfma_f32_16x16x32_bf16 v[168:171], v[184:187], v[36:39], v[168:171]
    v_mfma_f32_16x16x32_bf16 v[172:175], v[184:187], v[52:55], v[172:175]
    s_waitcnt lgkmcnt(4)
    v_mfma_f32_16x16x32_bf16 v[164:167], v[188:191], v[16:19], v[164:167]
    ds_read_b64 v[184:185], v232 offset:640
    ds_read_b64 v[186:187], v232 offset:648
    v_mfma_f32_16x16x32_bf16 v[168:171], v[188:191], v[32:35], v[168:171]
    v_mfma_f32_16x16x32_bf16 v[172:175], v[188:191], v[48:51], v[172:175]
    s_waitcnt lgkmcnt(4)
    v_mfma_f32_16x16x32_bf16 v[168:171], v[176:179], v[28:31], v[168:171]
    ds_read_b64 v[188:189], v232 offset:512
    ds_read_b64 v[190:191], v232 offset:520
    v_mfma_f32_16x16x32_bf16 v[172:175], v[176:179], v[44:47], v[172:175]
    s_waitcnt lgkmcnt(4)
    v_mfma_f32_16x16x32_bf16 v[168:171], v[180:183], v[24:27], v[168:171]
    ds_read_b64 v[176:177], v232 offset:384
    ds_read_b64 v[178:179], v232 offset:392
    v_mfma_f32_16x16x32_bf16 v[172:175], v[180:183], v[40:43], v[172:175]
    s_waitcnt lgkmcnt(4)
    v_mfma_f32_16x16x32_bf16 v[168:171], v[184:187], v[20:23], v[168:171]
    ds_read_b64 v[180:181], v232 offset:256
    ds_read_b64 v[182:183], v232 offset:264
    v_mfma_f32_16x16x32_bf16 v[172:175], v[184:187], v[36:39], v[172:175]
    s_waitcnt lgkmcnt(4)
    v_mfma_f32_16x16x32_bf16 v[168:171], v[188:191], v[16:19], v[168:171]
    ds_read_b64 v[184:185], v232 offset:128
    ds_read_b64 v[186:187], v232 offset:136
    v_mfma_f32_16x16x32_bf16 v[172:175], v[188:191], v[32:35], v[172:175]
    s_waitcnt lgkmcnt(4)
    v_mfma_f32_16x16x32_bf16 v[172:175], v[176:179], v[28:31], v[172:175]
    ds_read_b64 v[188:189], v232 offset:0
    ds_read_b64 v[190:191], v232 offset:8
    s_waitcnt lgkmcnt(4)
    v_mfma_f32_16x16x32_bf16 v[172:175], v[180:183], v[24:27], v[172:175]
    s_waitcnt lgkmcnt(2)
    v_mfma_f32_16x16x32_bf16 v[172:175], v[184:187], v[20:23], v[172:175]
    s_waitcnt lgkmcnt(0)
    v_mfma_f32_16x16x32_bf16 v[172:175], v[188:191], v[16:19], v[172:175]
    s_nop 7
    ds_write_b128 v234, v[144:147] offset:0
    ds_write_b128 v234, v[148:151] offset:1024
    ds_write_b128 v234, v[152:155] offset:2048
    ds_write_b128 v234, v[156:159] offset:3072
    ds_write_b128 v234, v[160:163] offset:4096
    ds_write_b128 v234, v[164:167] offset:5120
    ds_write_b128 v234, v[168:171] offset:6144
    ds_write_b128 v234, v[172:175] offset:7168
    s_branch L_J
L_G:
    v_and_b32 v13, 15, v1
    v_lshrrev_b32 v14, 4, v1
    v_lshrrev_b32 v3, 1, v13
    v_xor_b32 v3, v3, v14
    v_lshlrev_b32 v3, 4, v3
    v_lshl_add_u32 v3, v13, 7, v3
    s_lshr_b32 s55, s32, 1
    s_lshl_b32 s56, s55, 13
    v_add_u32 v3, s56, v3
    v_xor_b32 v4, 64, v3
    s_lshl_b32 s56, s55, 10
    s_add_u32 s56, s56, 157184
    v_lshl_add_u32 v9, v13, 4, s56
    s_and_b32 s53, s32, 1
    s_lshl_b32 s56, s53, 8
    s_add_u32 s56, s56, 159232
    v_lshl_add_u32 v10, v14, 4, s56
    v_lshrrev_b32 v13, 2, v13
    v_and_b32 v5, 1, v14
    v_lshl_or_b32 v5, v5, 2, v13
    s_lshl_b32 s56, s53, 2
    v_xor_b32 v5, s56, v5
    v_lshlrev_b32 v5, 5, v5
    v_lshl_add_u32 v13, v14, 3, v13
    v_lshl_add_u32 v5, v13, 8, v5
    v_and_b32 v13, 3, v1
    v_lshl_add_u32 v5, v13, 3, v5
    v_add_u32 v5, 49152, v5
    v_xor_b32 v6, 32, v5
    v_xor_b32 v7, 64, v5
    v_xor_b32 v8, 96, v5
    s_lshl_b32 s78, s55, 2
    s_lshl_b32 s56, s33, 3
    s_add_u32 s78, s78, s56
    s_mul_i32 s78, s78, 56
    s_lshl_b32 s56, s34, 2
    s_add_u32 s78, s78, s56
    s_lshl_b32 s56, s53, 1
    s_add_u32 s78, s78, s56
    s_lshl_b32 s78, s78, 10
    s_add_u32 s78, s78, 4194304
    v_lshlrev_b32 v11, 4, v1
    s_and_b32 s53, s32, 3
    s_mov_b32 s54, 114688
    s_cmp_eq_u32 s53, 1
    s_cmov_b32 s54, 130192
    s_cmp_eq_u32 s53, 2
    s_cmov_b32 s54, 32768
    s_cmp_eq_u32 s53, 3
    s_cmov_b32 s54, 145696
    v_add_u32 v12, s54, v2
    s_and_b32 s54, s53, 1
    s_lshl_b32 s54, s54, 4
    s_sub_u32 s84, 16, s54
    s_lshr_b32 s54, s53, 1
    s_lshl_b32 s54, s54, 4
    s_sub_u32 s85, 16, s54
    s_mul_i32 s71, s32, 229376
    s_lshl_b32 s53, s58, 7
    s_add_u32 s71, s71, s53
    s_lshl_b32 s72, s32, 12
    s_lshl_b32 s77, s57, 16
    s_add_u32 s77, s77, s53
    s_lshl_b32 s54, s32, 13
    s_add_u32 s77, s77, s54
    s_lshr_b32 s53, s2, 2
    s_and_b32 s53, s53, 6
    s_and_b32 s54, s2, 7
    s_add_u32 s53, s53, s54
    s_sub_u32 s54, s53, 7
    s_cmp_ge_u32 s53, 7
    s_cselect_b32 s53, s54, s53
    s_lshl_b32 s64, s53, 10
    s_add_u32 s53, s53, 1
    s_sub_u32 s54, s53, 7
    s_cmp_ge_u32 s53, 7
    s_cselect_b32 s53, s54, s53
    s_lshl_b32 s65, s53, 10
    s_add_u32 s53, s53, 1
    s_sub_u32 s54, s53, 7
    s_cmp_ge_u32 s53, 7
    s_cselect_b32 s53, s54, s53
    s_lshl_b32 s66, s53, 10
    s_add_u32 s53, s53, 1
    s_sub_u32 s54, s53, 7
    s_cmp_ge_u32 s53, 7
    s_cselect_b32 s53, s54, s53
    s_lshl_b32 s67, s53, 10
    s_add_u32 s53, s53, 1
    s_sub_u32 s54, s53, 7
    s_cmp_ge_u32 s53, 7
    s_cselect_b32 s53, s54, s53
    s_lshl_b32 s68, s53, 10
    s_add_u32 s53, s53, 1
    s_sub_u32 s54, s53, 7
    s_cmp_ge_u32 s53, 7
    s_cselect_b32 s53, s54, s53
    s_lshl_b32 s69, s53, 10
    s_add_u32 s53, s53, 1
    s_sub_u32 s54, s53, 7
    s_cmp_ge_u32 s53, 7
    s_cselect_b32 s53, s54, s53
    s_lshl_b32 s70, s53, 10
    s_mul_i32 s53, s57, 224
    s_mul_i32 s54, s32, 7
    s_add_u32 s53, s53, s54
    s_lshl_b32 s53, s53, 10
    s_add_u32 s53, s53, 4194304
    s_add_u32 s73, s58, 0
    s_and_b32 s73, s73, 3
    s_mul_i32 s73, s73, 57344
    s_add_u32 s73, s73, s53
    s_add_u32 s74, s58, 1
    s_and_b32 s74, s74, 3
    s_mul_i32 s74, s74, 57344
    s_add_u32 s74, s74, s53
    s_add_u32 s75, s58, 2
    s_and_b32 s75, s75, 3
    s_mul_i32 s75, s75, 57344
    s_add_u32 s75, s75, s53
    s_add_u32 s76, s58, 3
    s_and_b32 s76, s76, 3
    s_mul_i32 s76, s76, 57344
    s_add_u32 s76, s76, s53
    v_lshrrev_b32 v13, 4, v1
    v_lshlrev_b32 v13, 1, v13
    v_xor_b32 v13, v13, v1
    v_and_b32 v13, 7, v13
    v_lshrrev_b32 v14, 3, v1
    v_lshlrev_b32 v244, 10, v14
    v_lshl_add_u32 v244, v13, 4, v244
    v_and_b32 v14, 3, v14
    v_lshlrev_b32 v14, 5, v14
    v_lshrrev_b32 v13, 2, v1
    v_lshl_add_u32 v14, v13, 7, v14
    v_and_b32 v249, 3, v1
    v_lshl_add_u32 v14, v249, 3, v14
    v_add_u32 v245, s72, v14
    v_xor_b32 v246, 32, v245
    v_xor_b32 v247, 64, v245
    v_xor_b32 v248, 96, v245
    v_lshl_add_u32 v13, v249, 2, v13
    v_and_b32 v13, 15, v13
    v_lshl_add_u32 v13, v249, 4, v13
    s_lshl_b32 s53, s32, 10
    s_add_u32 s53, s53, 65536
    v_lshl_add_u32 v249, v13, 4, s53
    v_lshlrev_b32 v250, 3, v0
    v_add_u32 v250, 148480, v250
    s_waitcnt vmcnt(0) lgkmcnt(0)
    s_lshl_b32 s55, s59, s85
    s_and_b32 s55, s55, 0xffff0000
    v_lshlrev_b32 v16, s84, v240
    v_lshlrev_b32 v17, s84, v241
    v_lshlrev_b32 v18, s84, v242
    v_lshlrev_b32 v19, s84, v243
    v_and_b32 v16, 0xffff0000, v16
    v_and_b32 v17, 0xffff0000, v17
    v_and_b32 v18, 0xffff0000, v18
    v_and_b32 v19, 0xffff0000, v19
    v_mov_b32 v20, 0x3fb8aa3b
    v_mul_f32 v20, s55, v20
    v_mul_f32 v21, 0x3fb8aa3b, v16
    v_exp_f32 v20, v20
    v_exp_f32 v21, v21
    s_nop 0
    v_cvt_pk_bf16_f32 v20, v20, v20
    v_lshlrev_b32 v20, 16, v20
    v_cvt_pk_bf16_f32 v21, v21, v21
    v_lshlrev_b32 v21, 16, v21
    v_mul_f32 v21, v21, v20
    v_mul_f32 v22, v17, v20
    v_mul_f32 v21, 0xbfb8aa3b, v21
    v_mul_f32 v22, 0x3e22f983, v22
    v_add_f32 v20, v20, v20
    v_mul_f32 v24, v18, v20
    v_mul_f32 v25, -v19, v20
    v_mul_f32 v32, 0x41000000, v21
    v_mul_f32 v33, 0x41000000, v22
    v_mul_f32 v34, 1.0, v21
    v_mul_f32 v35, 1.0, v22
    v_mul_f32 v36, 0x43000000, v21
    v_mul_f32 v37, 0x43000000, v22
    v_mul_f32 v38, 0x42800000, v21
    v_mul_f32 v39, 0x42800000, v22
    v_exp_f32 v32, v32
    v_fract_f32 v33, v33
    v_exp_f32 v34, v34
    v_fract_f32 v35, v35
    v_exp_f32 v36, v36
    v_fract_f32 v37, v37
    v_exp_f32 v38, v38
    v_fract_f32 v39, v39
    v_cos_f32 v40, v33
    v_sin_f32 v41, v33
    v_cos_f32 v42, v35
    v_sin_f32 v43, v35
    v_cos_f32 v44, v37
    v_sin_f32 v45, v37
    v_cos_f32 v46, v39
    v_sin_f32 v47, v39
    s_nop 0
    v_mul_f32 v40, v40, v32
    v_mul_f32 v41, -v41, v32
    v_mul_f32 v42, v42, v34
    v_mul_f32 v43, v43, v34
    v_mul_f32 v44, v44, v36
    v_mul_f32 v45, v45, v36
    v_mul_f32 v46, v46, v38
    v_mul_f32 v47, -v47, v38
    v_mov_b32 v16, 0x00003f80
    ds_write_b32 v12, v16 offset:4352
    v_pk_mul_f32 v[28:29], v[24:25], v[46:47] op_sel:[0,0] op_sel_hi:[0,1]
    v_cvt_pk_bf16_f32 v66, v24, v25
    v_cvt_pk_bf16_f32 v68, v42, v43
    v_pk_fma_f32 v[28:29], v[24:25], v[46:47], v[28:29] op_sel:[1,1,0] op_sel_hi:[1,0,1] neg_lo:[0,1,0]
    ds_write_b32 v12, v66 offset:0
    ds_write_b32 v12, v68 offset:4624
    v_cvt_pk_bf16_f32 v64, v28, v29
    v_pk_mul_f32 v[26:27], v[24:25], v[40:41] op_sel:[0,0] op_sel_hi:[0,1]
    v_cvt_pk_bf16_f32 v69, v44, v45
    ds_write_b32 v12, v64 offset:2176
    v_pk_fma_f32 v[26:27], v[24:25], v[40:41], v[26:27] op_sel:[1,1,0] op_sel_hi:[1,0,1] neg_lo:[0,1,0]
    ds_write_b32 v12, v69 offset:6528
    v_pk_mul_f32 v[30:31], v[28:29], v[40:41] op_sel:[0,0] op_sel_hi:[0,1]
    v_cvt_pk_bf16_f32 v67, v26, v27
    v_pk_mul_f32 v[48:49], v[42:43], v[42:43] op_sel:[0,0] op_sel_hi:[0,1]
    v_pk_fma_f32 v[30:31], v[28:29], v[40:41], v[30:31] op_sel:[1,1,0] op_sel_hi:[1,0,1] neg_lo:[0,1,0]
    ds_write_b32 v12, v67 offset:272
    v_pk_fma_f32 v[48:49], v[42:43], v[42:43], v[48:49] op_sel:[1,1,0] op_sel_hi:[1,0,1] neg_lo:[0,1,0]
    v_cvt_pk_bf16_f32 v65, v30, v31
    v_pk_mul_f32 v[24:25], v[26:27], v[40:41] op_sel:[0,0] op_sel_hi:[0,1]
    v_cvt_pk_bf16_f32 v68, v48, v49
    ds_write_b32 v12, v65 offset:2448
    v_pk_fma_f32 v[24:25], v[26:27], v[40:41], v[24:25] op_sel:[1,1,0] op_sel_hi:[1,0,1] neg_lo:[0,1,0]
    ds_write_b32 v12, v68 offset:4896
    v_pk_mul_f32 v[28:29], v[30:31], v[40:41] op_sel:[0,0] op_sel_hi:[0,1]
    v_cvt_pk_bf16_f32 v66, v24, v25
    v_pk_mul_f32 v[50:51], v[48:49], v[42:43] op_sel:[0,0] op_sel_hi:[0,1]
    v_pk_fma_f32 v[28:29], v[30:31], v[40:41], v[28:29] op_sel:[1,1,0] op_sel_hi:[1,0,1] neg_lo:[0,1,0]
    ds_write_b32 v12, v66 offset:544
    v_pk_fma_f32 v[50:51], v[48:49], v[42:43], v[50:51] op_sel:[1,1,0] op_sel_hi:[1,0,1] neg_lo:[0,1,0]
    v_cvt_pk_bf16_f32 v64, v28, v29
    v_pk_mul_f32 v[26:27], v[24:25], v[40:41] op_sel:[0,0] op_sel_hi:[0,1]
    v_cvt_pk_bf16_f32 v69, v50, v51
    ds_write_b32 v12, v64 offset:2720
    v_pk_fma_f32 v[26:27], v[24:25], v[40:41], v[26:27] op_sel:[1,1,0] op_sel_hi:[1,0,1] neg_lo:[0,1,0]
    ds_write_b32 v12, v69 offset:5168
    v_pk_mul_f32 v[30:31], v[28:29], v[40:41] op_sel:[0,0] op_sel_hi:[0,1]
    v_cvt_pk_bf16_f32 v67, v26, v27
    v_pk_mul_f32 v[52:53], v[50:51], v[42:43] op_sel:[0,0] op_sel_hi:[0,1]
    v_pk_fma_f32 v[30:31], v[28:29], v[40:41], v[30:31] op_sel:[1,1,0] op_sel_hi:[1,0,1] neg_lo:[0,1,0]
    ds_write_b32 v12, v67 offset:816
    v_pk_fma_f32 v[52:53], v[50:51], v[42:43], v[52:53] op_sel:[1,1,0] op_sel_hi:[1,0,1] neg_lo:[0,1,0]
    v_cvt_pk_bf16_f32 v65, v30, v31
    v_pk_mul_f32 v[24:25], v[26:27], v[40:41] op_sel:[0,0] op_sel_hi:[0,1]
    v_cvt_pk_bf16_f32 v68, v52, v53
    ds_write_b32 v12, v65 offset:2992
    v_pk_fma_f32 v[24:25], v[26:27], v[40:41], v[24:25] op_sel:[1,1,0] op_sel_hi:[1,0,1] neg_lo:[0,1,0]
    ds_write_b32 v12, v68 offset:5440
    v_pk_mul_f32 v[28:29], v[30:31], v[40:41] op_sel:[0,0] op_sel_hi:[0,1]
    v_cvt_pk_bf16_f32 v66, v24, v25
    v_pk_mul_f32 v[54:55], v[52:53], v[42:43] op_sel:[0,0] op_sel_hi:[0,1]
    v_pk_fma_f32 v[28:29], v[30:31], v[40:41], v[28:29] op_sel:[1,1,0] op_sel_hi:[1,0,1] neg_lo:[0,1,0]
    ds_write_b32 v12, v66 offset:1088
    v_pk_fma_f32 v[54:55], v[52:53], v[42:43], v[54:55] op_sel:[1,1,0] op_sel_hi:[1,0,1] neg_lo:[0,1,0]
    v_cvt_pk_bf16_f32 v64, v28, v29
    v_pk_mul_f32 v[26:27], v[24:25], v[40:41] op_sel:[0,0] op_sel_hi:[0,1]
    v_cvt_pk_bf16_f32 v69, v54, v55
    ds_write_b32 v12, v64 offset:3264
    v_pk_fma_f32 v[26:27], v[24:25], v[40:41], v[26:27] op_sel:[1,1,0] op_sel_hi:[1,0,1] neg_lo:[0,1,0]
    ds_write_b32 v12, v69 offset:5712
    v_pk_mul_f32 v[30:31], v[28:29], v[40:41] op_sel:[0,0] op_sel_hi:[0,1]
    v_cvt_pk_bf16_f32 v67, v26, v27
    v_pk_mul_f32 v[56:57], v[54:55], v[42:43] op_sel:[0,0] op_sel_hi:[0,1]
    v_pk_fma_f32 v[30:31], v[28:29], v[40:41], v[30:31] op_sel:[1,1,0] op_sel_hi:[1,0,1] neg_lo:[0,1,0]
    ds_write_b32 v12, v67 offset:1360
    v_pk_fma_f32 v[56:57], v[54:55], v[42:43], v[56:57] op_sel:[1,1,0] op_sel_hi:[1,0,1] neg_lo:[0,1,0]
    v_cvt_pk_bf16_f32 v65, v30, v31
    v_pk_mul_f32 v[24:25], v[26:27], v[40:41] op_sel:[0,0] op_sel_hi:[0,1]
    v_cvt_pk_bf16_f32 v68, v56, v57
    ds_write_b32 v12, v65 offset:3536
    v_pk_fma_f32 v[24:25], v[26:27], v[40:41], v[24:25] op_sel:[1,1,0] op_sel_hi:[1,0,1] neg_lo:[0,1,0]
    ds_write_b32 v12, v68 offset:5984
    v_pk_mul_f32 v[28:29], v[30:31], v[40:41] op_sel:[0,0] op_sel_hi:[0,1]
    v_cvt_pk_bf16_f32 v66, v24, v25
    v_pk_mul_f32 v[58:59], v[56:57], v[42:43] op_sel:[0,0] op_sel_hi:[0,1]
    v_pk_fma_f32 v[28:29], v[30:31], v[40:41], v[28:29] op_sel:[1,1,0] op_sel_hi:[1,0,1] neg_lo:[0,1,0]
    ds_write_b32 v12, v66 offset:1632
    v_pk_fma_f32 v[58:59], v[56:57], v[42:43], v[58:59] op_sel:[1,1,0] op_sel_hi:[1,0,1] neg_lo:[0,1,0]
    v_cvt_pk_bf16_f32 v64, v28, v29
    v_pk_mul_f32 v[26:27], v[24:25], v[40:41] op_sel:[0,0] op_sel_hi:[0,1]
    v_cvt_pk_bf16_f32 v69, v58, v59
    ds_write_b32 v12, v64 offset:3808
    v_pk_fma_f32 v[26:27], v[24:25], v[40:41], v[26:27] op_sel:[1,1,0] op_sel_hi:[1,0,1] neg_lo:[0,1,0]
    ds_write_b32 v12, v69 offset:6256
    v_pk_mul_f32 v[30:31], v[28:29], v[40:41] op_sel:[0,0] op_sel_hi:[0,1]
    v_cvt_pk_bf16_f32 v67, v26, v27
    v_pk_fma_f32 v[30:31], v[28:29], v[40:41], v[30:31] op_sel:[1,1,0] op_sel_hi:[1,0,1] neg_lo:[0,1,0]
    ds_write_b32 v12, v67 offset:1904
    v_cvt_pk_bf16_f32 v65, v30, v31
    ds_write_b32 v12, v65 offset:4080
    v_pk_mul_f32 v[60:61], v[42:43], v[44:45] op_sel:[0,0] op_sel_hi:[0,1]
    v_pk_mul_f32 v[62:63], v[48:49], v[44:45] op_sel:[0,0] op_sel_hi:[0,1]
    v_pk_fma_f32 v[60:61], v[42:43], v[44:45], v[60:61] op_sel:[1,1,0] op_sel_hi:[1,0,1] neg_lo:[0,1,0]
    v_pk_fma_f32 v[62:63], v[48:49], v[44:45], v[62:63] op_sel:[1,1,0] op_sel_hi:[1,0,1] neg_lo:[0,1,0]
    v_cvt_pk_bf16_f32 v64, v60, v61
    v_cvt_pk_bf16_f32 v66, v62, v63
    ds_write_b32 v12, v64 offset:6800
    ds_write_b32 v12, v66 offset:7072
    v_pk_mul_f32 v[60:61], v[50:51], v[44:45] op_sel:[0,0] op_sel_hi:[0,1]
    v_pk_mul_f32 v[62:63], v[52:53], v[44:45] op_sel:[0,0] op_sel_hi:[0,1]
    v_pk_fma_f32 v[60:61], v[50:51], v[44:45], v[60:61] op_sel:[1,1,0] op_sel_hi:[1,0,1] neg_lo:[0,1,0]
    v_pk_fma_f32 v[62:63], v[52:53], v[44:45], v[62:63] op_sel:[1,1,0] op_sel_hi:[1,0,1] neg_lo:[0,1,0]
    v_cvt_pk_bf16_f32 v65, v60, v61
    v_cvt_pk_bf16_f32 v67, v62, v63
    ds_write_b32 v12, v65 offset:7344
    ds_write_b32 v12, v67 offset:7616
    v_pk_mul_f32 v[60:61], v[54:55], v[44:45] op_sel:[0,0] op_sel_hi:[0,1]
    v_pk_mul_f32 v[62:63], v[56:57], v[44:45] op_sel:[0,0] op_sel_hi:[0,1]
    v_pk_fma_f32 v[60:61], v[54:55], v[44:45], v[60:61] op_sel:[1,1,0] op_sel_hi:[1,0,1] neg_lo:[0,1,0]
    v_pk_fma_f32 v[62:63], v[56:57], v[44:45], v[62:63] op_sel:[1,1,0] op_sel_hi:[1,0,1] neg_lo:[0,1,0]
    v_cvt_pk_bf16_f32 v64, v60, v61
    v_cvt_pk_bf16_f32 v66, v62, v63
    ds_write_b32 v12, v64 offset:7888
    ds_write_b32 v12, v66 offset:8160
    v_pk_mul_f32 v[60:61], v[58:59], v[44:45] op_sel:[0,0] op_sel_hi:[0,1]
    v_pk_fma_f32 v[60:61], v[58:59], v[44:45], v[60:61] op_sel:[1,1,0] op_sel_hi:[1,0,1] neg_lo:[0,1,0]
    v_cvt_pk_bf16_f32 v65, v60, v61
    ds_write_b32 v12, v65 offset:8432
    s_waitcnt lgkmcnt(0)
    s_barrier
    ds_read_b128 v[16:19], v3 offset:0
    ds_read_b128 v[20:23], v3 offset:2048
    ds_read_b128 v[24:27], v3 offset:4096
    ds_read_b128 v[28:31], v3 offset:6144
    ds_read_b64_tr_b16 v[32:33], v5 offset:0
    ds_read_b64_tr_b16 v[34:35], v5 offset:1024
    ds_read_b64_tr_b16 v[36:37], v6 offset:0
    ds_read_b64_tr_b16 v[38:39], v6 offset:1024
    ds_read_b64_tr_b16 v[40:41], v7 offset:0
    ds_read_b64_tr_b16 v[42:43], v7 offset:1024
    ds_read_b64_tr_b16 v[44:45], v8 offset:0
    ds_read_b64_tr_b16 v[46:47], v8 offset:1024
    ds_read_b64_tr_b16 v[48:49], v5 offset:8192
    ds_read_b64_tr_b16 v[50:51], v5 offset:9216
    ds_read_b64_tr_b16 v[52:53], v6 offset:8192
    ds_read_b64_tr_b16 v[54:55], v6 offset:9216
    ds_read_b64_tr_b16 v[56:57], v7 offset:8192
    ds_read_b64_tr_b16 v[58:59], v7 offset:9216
    ds_read_b64_tr_b16 v[60:61], v8 offset:8192
    ds_read_b64_tr_b16 v[62:63], v8 offset:9216
    s_waitcnt lgkmcnt(0)
    s_barrier
    v_mfma_f32_16x16x32_bf16 v[112:115], v[32:35], v[16:19], 0
    ds_read_b128 v[64:67], v4 offset:0
    v_mfma_f32_16x16x32_bf16 v[116:119], v[36:39], v[16:19], 0
    ds_read_b128 v[68:71], v4 offset:2048
    v_mfma_f32_16x16x32_bf16 v[120:123], v[40:43], v[16:19], 0
    ds_read_b128 v[72:75], v4 offset:4096
    v_mfma_f32_16x16x32_bf16 v[124:127], v[44:47], v[16:19], 0
    ds_read_b128 v[76:79], v4 offset:6144
    v_mfma_f32_16x16x32_bf16 v[128:131], v[48:51], v[16:19], 0
    ds_read_b64_tr_b16 v[80:81], v5 offset:16384
    v_mfma_f32_16x16x32_bf16 v[132:135], v[52:55], v[16:19], 0
    ds_read_b64_tr_b16 v[82:83], v5 offset:17408
    v_mfma_f32_16x16x32_bf16 v[136:139], v[56:59], v[16:19], 0
    ds_read_b64_tr_b16 v[84:85], v6 offset:16384
    v_mfma_f32_16x16x32_bf16 v[140:143], v[60:63], v[16:19], 0
    ds_read_b64_tr_b16 v[86:87], v6 offset:17408
    v_mfma_f32_16x16x32_bf16 v[144:147], v[32:35], v[20:23], 0
    ds_read_b64_tr_b16 v[88:89], v7 offset:16384
    v_mfma_f32_16x16x32_bf16 v[148:151], v[36:39], v[20:23], 0
    ds_read_b64_tr_b16 v[90:91], v7 offset:17408
    v_mfma_f32_16x16x32_bf16 v[152:155], v[40:43], v[20:23], 0
    ds_read_b64_tr_b16 v[92:93], v8 offset:16384
    v_mfma_f32_16x16x32_bf16 v[156:159], v[44:47], v[20:23], 0
    ds_read_b64_tr_b16 v[94:95], v8 offset:17408
    v_mfma_f32_16x16x32_bf16 v[160:163], v[48:51], v[20:23], 0
    ds_read_b64_tr_b16 v[96:97], v5 offset:24576
    v_mfma_f32_16x16x32_bf16 v[164:167], v[52:55], v[20:23], 0
    ds_read_b64_tr_b16 v[98:99], v5 offset:25600
    v_mfma_f32_16x16x32_bf16 v[168:171], v[56:59], v[20:23], 0
    ds_read_b64_tr_b16 v[100:101], v6 offset:24576
    v_mfma_f32_16x16x32_bf16 v[172:175], v[60:63], v[20:23], 0
    ds_read_b64_tr_b16 v[102:103], v6 offset:25600
    v_mfma_f32_16x16x32_bf16 v[176:179], v[32:35], v[24:27], 0
    ds_read_b64_tr_b16 v[104:105], v7 offset:24576
    v_mfma_f32_16x16x32_bf16 v[180:183], v[36:39], v[24:27], 0
    ds_read_b64_tr_b16 v[106:107], v7 offset:25600
    v_mfma_f32_16x16x32_bf16 v[184:187], v[40:43], v[24:27], 0
    ds_read_b64_tr_b16 v[108:109], v8 offset:24576
    v_mfma_f32_16x16x32_bf16 v[188:191], v[44:47], v[24:27], 0
    ds_read_b64_tr_b16 v[110:111], v8 offset:25600
    v_mfma_f32_16x16x32_bf16 v[192:195], v[48:51], v[24:27], 0
    v_mfma_f32_16x16x32_bf16 v[196:199], v[52:55], v[24:27], 0
    v_mfma_f32_16x16x32_bf16 v[200:203], v[56:59], v[24:27], 0
    v_mfma_f32_16x16x32_bf16 v[204:207], v[60:63], v[24:27], 0
    v_mfma_f32_16x16x32_bf16 v[208:211], v[32:35], v[28:31], 0
    v_mfma_f32_16x16x32_bf16 v[212:215], v[36:39], v[28:31], 0
    v_mfma_f32_16x16x32_bf16 v[216:219], v[40:43], v[28:31], 0
    v_mfma_f32_16x16x32_bf16 v[220:223], v[44:47], v[28:31], 0
    v_mfma_f32_16x16x32_bf16 v[224:227], v[48:51], v[28:31], 0
    v_mfma_f32_16x16x32_bf16 v[228:231], v[52:55], v[28:31], 0
    v_mfma_f32_16x16x32_bf16 v[232:235], v[56:59], v[28:31], 0
    v_mfma_f32_16x16x32_bf16 v[236:239], v[60:63], v[28:31], 0
    s_waitcnt lgkmcnt(0)
    s_barrier
    v_mfma_f32_16x16x32_bf16 v[112:115], v[80:83], v[64:67], v[112:115]
    ds_read_b128 v[16:19], v3 offset:16384
    v_mfma_f32_16x16x32_bf16 v[116:119], v[84:87], v[64:67], v[116:119]
    ds_read_b128 v[20:23], v3 offset:18432
    v_mfma_f32_16x16x32_bf16 v[120:123], v[88:91], v[64:67], v[120:123]
    ds_read_b128 v[24:27], v3 offset:20480
    v_mfma_f32_16x16x32_bf16 v[124:127], v[92:95], v[64:67], v[124:127]
    ds_read_b128 v[28:31], v3 offset:22528
    v_mfma_f32_16x16x32_bf16 v[128:131], v[96:99], v[64:67], v[128:131]
    ds_read_b64_tr_b16 v[32:33], v5 offset:32768
    v_mfma_f32_16x16x32_bf16 v[132:135], v[100:103], v[64:67], v[132:135]
    ds_read_b64_tr_b16 v[34:35], v5 offset:33792
    v_mfma_f32_16x16x32_bf16 v[136:139], v[104:107], v[64:67], v[136:139]
    ds_read_b64_tr_b16 v[36:37], v6 offset:32768
    v_mfma_f32_16x16x32_bf16 v[140:143], v[108:111], v[64:67], v[140:143]
    ds_read_b64_tr_b16 v[38:39], v6 offset:33792
    v_mfma_f32_16x16x32_bf16 v[144:147], v[80:83], v[68:71], v[144:147]
    ds_read_b64_tr_b16 v[40:41], v7 offset:32768
    v_mfma_f32_16x16x32_bf16 v[148:151], v[84:87], v[68:71], v[148:151]
    ds_read_b64_tr_b16 v[42:43], v7 offset:33792
    v_mfma_f32_16x16x32_bf16 v[152:155], v[88:91], v[68:71], v[152:155]
    ds_read_b64_tr_b16 v[44:45], v8 offset:32768
    v_mfma_f32_16x16x32_bf16 v[156:159], v[92:95], v[68:71], v[156:159]
    ds_read_b64_tr_b16 v[46:47], v8 offset:33792
    v_mfma_f32_16x16x32_bf16 v[160:163], v[96:99], v[68:71], v[160:163]
    ds_read_b64_tr_b16 v[48:49], v5 offset:40960
    v_mfma_f32_16x16x32_bf16 v[164:167], v[100:103], v[68:71], v[164:167]
    ds_read_b64_tr_b16 v[50:51], v5 offset:41984
    v_mfma_f32_16x16x32_bf16 v[168:171], v[104:107], v[68:71], v[168:171]
    ds_read_b64_tr_b16 v[52:53], v6 offset:40960
    v_mfma_f32_16x16x32_bf16 v[172:175], v[108:111], v[68:71], v[172:175]
    ds_read_b64_tr_b16 v[54:55], v6 offset:41984
    v_mfma_f32_16x16x32_bf16 v[176:179], v[80:83], v[72:75], v[176:179]
    ds_read_b64_tr_b16 v[56:57], v7 offset:40960
    v_mfma_f32_16x16x32_bf16 v[180:183], v[84:87], v[72:75], v[180:183]
    ds_read_b64_tr_b16 v[58:59], v7 offset:41984
    v_mfma_f32_16x16x32_bf16 v[184:187], v[88:91], v[72:75], v[184:187]
    ds_read_b64_tr_b16 v[60:61], v8 offset:40960
    v_mfma_f32_16x16x32_bf16 v[188:191], v[92:95], v[72:75], v[188:191]
    ds_read_b64_tr_b16 v[62:63], v8 offset:41984
    v_mfma_f32_16x16x32_bf16 v[192:195], v[96:99], v[72:75], v[192:195]
    v_mfma_f32_16x16x32_bf16 v[196:199], v[100:103], v[72:75], v[196:199]
    v_mfma_f32_16x16x32_bf16 v[200:203], v[104:107], v[72:75], v[200:203]
    v_mfma_f32_16x16x32_bf16 v[204:207], v[108:111], v[72:75], v[204:207]
    v_mfma_f32_16x16x32_bf16 v[208:211], v[80:83], v[76:79], v[208:211]
    v_mfma_f32_16x16x32_bf16 v[212:215], v[84:87], v[76:79], v[212:215]
    v_mfma_f32_16x16x32_bf16 v[216:219], v[88:91], v[76:79], v[216:219]
    v_mfma_f32_16x16x32_bf16 v[220:223], v[92:95], v[76:79], v[220:223]
    v_mfma_f32_16x16x32_bf16 v[224:227], v[96:99], v[76:79], v[224:227]
    v_mfma_f32_16x16x32_bf16 v[228:231], v[100:103], v[76:79], v[228:231]
    v_mfma_f32_16x16x32_bf16 v[232:235], v[104:107], v[76:79], v[232:235]
    v_mfma_f32_16x16x32_bf16 v[236:239], v[108:111], v[76:79], v[236:239]
    s_waitcnt lgkmcnt(0)
    s_barrier
    v_mfma_f32_16x16x32_bf16 v[112:115], v[32:35], v[16:19], v[112:115]
    ds_read_b128 v[64:67], v4 offset:16384
    v_mfma_f32_16x16x32_bf16 v[116:119], v[36:39], v[16:19], v[116:119]
    ds_read_b128 v[68:71], v4 offset:18432
    v_mfma_f32_16x16x32_bf16 v[120:123], v[40:43], v[16:19], v[120:123]
    ds_read_b128 v[72:75], v4 offset:20480
    v_mfma_f32_16x16x32_bf16 v[124:127], v[44:47], v[16:19], v[124:127]
    ds_read_b128 v[76:79], v4 offset:22528
    v_mfma_f32_16x16x32_bf16 v[128:131], v[48:51], v[16:19], v[128:131]
    ds_read_b64_tr_b16 v[80:81], v5 offset:49152
    v_mfma_f32_16x16x32_bf16 v[132:135], v[52:55], v[16:19], v[132:135]
    ds_read_b64_tr_b16 v[82:83], v5 offset:50176
    v_mfma_f32_16x16x32_bf16 v[136:139], v[56:59], v[16:19], v[136:139]
    ds_read_b64_tr_b16 v[84:85], v6 offset:49152
    v_mfma_f32_16x16x32_bf16 v[140:143], v[60:63], v[16:19], v[140:143]
    ds_read_b64_tr_b16 v[86:87], v6 offset:50176
    v_mfma_f32_16x16x32_bf16 v[144:147], v[32:35], v[20:23], v[144:147]
    ds_read_b64_tr_b16 v[88:89], v7 offset:49152
    v_mfma_f32_16x16x32_bf16 v[148:151], v[36:39], v[20:23], v[148:151]
    ds_read_b64_tr_b16 v[90:91], v7 offset:50176
    v_mfma_f32_16x16x32_bf16 v[152:155], v[40:43], v[20:23], v[152:155]
    ds_read_b64_tr_b16 v[92:93], v8 offset:49152
    v_mfma_f32_16x16x32_bf16 v[156:159], v[44:47], v[20:23], v[156:159]
    ds_read_b64_tr_b16 v[94:95], v8 offset:50176
    v_mfma_f32_16x16x32_bf16 v[160:163], v[48:51], v[20:23], v[160:163]
    ds_read_b64_tr_b16 v[96:97], v5 offset:57344
    v_mfma_f32_16x16x32_bf16 v[164:167], v[52:55], v[20:23], v[164:167]
    ds_read_b64_tr_b16 v[98:99], v5 offset:58368
    v_mfma_f32_16x16x32_bf16 v[168:171], v[56:59], v[20:23], v[168:171]
    ds_read_b64_tr_b16 v[100:101], v6 offset:57344
    v_mfma_f32_16x16x32_bf16 v[172:175], v[60:63], v[20:23], v[172:175]
    ds_read_b64_tr_b16 v[102:103], v6 offset:58368
    v_mfma_f32_16x16x32_bf16 v[176:179], v[32:35], v[24:27], v[176:179]
    ds_read_b64_tr_b16 v[104:105], v7 offset:57344
    v_mfma_f32_16x16x32_bf16 v[180:183], v[36:39], v[24:27], v[180:183]
    ds_read_b64_tr_b16 v[106:107], v7 offset:58368
    v_mfma_f32_16x16x32_bf16 v[184:187], v[40:43], v[24:27], v[184:187]
    ds_read_b64_tr_b16 v[108:109], v8 offset:57344
    v_mfma_f32_16x16x32_bf16 v[188:191], v[44:47], v[24:27], v[188:191]
    ds_read_b64_tr_b16 v[110:111], v8 offset:58368
    v_mfma_f32_16x16x32_bf16 v[192:195], v[48:51], v[24:27], v[192:195]
    v_mfma_f32_16x16x32_bf16 v[196:199], v[52:55], v[24:27], v[196:199]
    v_mfma_f32_16x16x32_bf16 v[200:203], v[56:59], v[24:27], v[200:203]
    v_mfma_f32_16x16x32_bf16 v[204:207], v[60:63], v[24:27], v[204:207]
    v_mfma_f32_16x16x32_bf16 v[208:211], v[32:35], v[28:31], v[208:211]
    v_mfma_f32_16x16x32_bf16 v[212:215], v[36:39], v[28:31], v[212:215]
    v_mfma_f32_16x16x32_bf16 v[216:219], v[40:43], v[28:31], v[216:219]
    v_mfma_f32_16x16x32_bf16 v[220:223], v[44:47], v[28:31], v[220:223]
    v_mfma_f32_16x16x32_bf16 v[224:227], v[48:51], v[28:31], v[224:227]
    v_mfma_f32_16x16x32_bf16 v[228:231], v[52:55], v[28:31], v[228:231]
    v_mfma_f32_16x16x32_bf16 v[232:235], v[56:59], v[28:31], v[232:235]
    v_mfma_f32_16x16x32_bf16 v[236:239], v[60:63], v[28:31], v[236:239]
    s_waitcnt lgkmcnt(0)
    s_barrier
    v_mfma_f32_16x16x32_bf16 v[112:115], v[80:83], v[64:67], v[112:115]
    ds_read_b128 v[16:19], v3 offset:32768
    v_mfma_f32_16x16x32_bf16 v[116:119], v[84:87], v[64:67], v[116:119]
    ds_read_b128 v[20:23], v3 offset:34816
    v_mfma_f32_16x16x32_bf16 v[120:123], v[88:91], v[64:67], v[120:123]
    ds_read_b128 v[24:27], v3 offset:36864
    v_mfma_f32_16x16x32_bf16 v[124:127], v[92:95], v[64:67], v[124:127]
    ds_read_b128 v[28:31], v3 offset:38912
    v_mfma_f32_16x16x32_bf16 v[128:131], v[96:99], v[64:67], v[128:131]
    ds_read_b64_tr_b16 v[32:33], v5 offset:0
    v_mfma_f32_16x16x32_bf16 v[132:135], v[100:103], v[64:67], v[132:135]
    ds_read_b64_tr_b16 v[34:35], v5 offset:1024
    v_mfma_f32_16x16x32_bf16 v[136:139], v[104:107], v[64:67], v[136:139]
    ds_read_b64_tr_b16 v[36:37], v6 offset:0
    v_mfma_f32_16x16x32_bf16 v[140:143], v[108:111], v[64:67], v[140:143]
    ds_read_b64_tr_b16 v[38:39], v6 offset:1024
    v_mfma_f32_16x16x32_bf16 v[144:147], v[80:83], v[68:71], v[144:147]
    ds_read_b64_tr_b16 v[40:41], v7 offset:0
    v_mfma_f32_16x16x32_bf16 v[148:151], v[84:87], v[68:71], v[148:151]
    ds_read_b64_tr_b16 v[42:43], v7 offset:1024
    v_mfma_f32_16x16x32_bf16 v[152:155], v[88:91], v[68:71], v[152:155]
    ds_read_b64_tr_b16 v[44:45], v8 offset:0
    v_mfma_f32_16x16x32_bf16 v[156:159], v[92:95], v[68:71], v[156:159]
    ds_read_b64_tr_b16 v[46:47], v8 offset:1024
    v_mfma_f32_16x16x32_bf16 v[160:163], v[96:99], v[68:71], v[160:163]
    ds_read_b64_tr_b16 v[48:49], v5 offset:8192
    v_mfma_f32_16x16x32_bf16 v[164:167], v[100:103], v[68:71], v[164:167]
    ds_read_b64_tr_b16 v[50:51], v5 offset:9216
    v_mfma_f32_16x16x32_bf16 v[168:171], v[104:107], v[68:71], v[168:171]
    ds_read_b64_tr_b16 v[52:53], v6 offset:8192
    v_mfma_f32_16x16x32_bf16 v[172:175], v[108:111], v[68:71], v[172:175]
    ds_read_b64_tr_b16 v[54:55], v6 offset:9216
    v_mfma_f32_16x16x32_bf16 v[176:179], v[80:83], v[72:75], v[176:179]
    ds_read_b64_tr_b16 v[56:57], v7 offset:8192
    v_mfma_f32_16x16x32_bf16 v[180:183], v[84:87], v[72:75], v[180:183]
    ds_read_b64_tr_b16 v[58:59], v7 offset:9216
    v_mfma_f32_16x16x32_bf16 v[184:187], v[88:91], v[72:75], v[184:187]
    ds_read_b64_tr_b16 v[60:61], v8 offset:8192
    v_mfma_f32_16x16x32_bf16 v[188:191], v[92:95], v[72:75], v[188:191]
    ds_read_b64_tr_b16 v[62:63], v8 offset:9216
    v_mfma_f32_16x16x32_bf16 v[192:195], v[96:99], v[72:75], v[192:195]
    v_mfma_f32_16x16x32_bf16 v[196:199], v[100:103], v[72:75], v[196:199]
    v_mfma_f32_16x16x32_bf16 v[200:203], v[104:107], v[72:75], v[200:203]
    v_mfma_f32_16x16x32_bf16 v[204:207], v[108:111], v[72:75], v[204:207]
    v_mfma_f32_16x16x32_bf16 v[208:211], v[80:83], v[76:79], v[208:211]
    v_mfma_f32_16x16x32_bf16 v[212:215], v[84:87], v[76:79], v[212:215]
    v_mfma_f32_16x16x32_bf16 v[216:219], v[88:91], v[76:79], v[216:219]
    v_mfma_f32_16x16x32_bf16 v[220:223], v[92:95], v[76:79], v[220:223]
    v_mfma_f32_16x16x32_bf16 v[224:227], v[96:99], v[76:79], v[224:227]
    v_mfma_f32_16x16x32_bf16 v[228:231], v[100:103], v[76:79], v[228:231]
    v_mfma_f32_16x16x32_bf16 v[232:235], v[104:107], v[76:79], v[232:235]
    v_mfma_f32_16x16x32_bf16 v[236:239], v[108:111], v[76:79], v[236:239]
    s_waitcnt lgkmcnt(0)
    s_barrier
    v_mfma_f32_16x16x32_bf16 v[112:115], v[32:35], v[16:19], v[112:115]
    ds_read_b128 v[64:67], v4 offset:32768
    v_mfma_f32_16x16x32_bf16 v[116:119], v[36:39], v[16:19], v[116:119]
    ds_read_b128 v[68:71], v4 offset:34816
    v_mfma_f32_16x16x32_bf16 v[120:123], v[40:43], v[16:19], v[120:123]
    ds_read_b128 v[72:75], v4 offset:36864
    v_mfma_f32_16x16x32_bf16 v[124:127], v[44:47], v[16:19], v[124:127]
    ds_read_b128 v[76:79], v4 offset:38912
    v_mfma_f32_16x16x32_bf16 v[128:131], v[48:51], v[16:19], v[128:131]
    ds_read_b64_tr_b16 v[80:81], v5 offset:16384
    v_mfma_f32_16x16x32_bf16 v[132:135], v[52:55], v[16:19], v[132:135]
    ds_read_b64_tr_b16 v[82:83], v5 offset:17408
    v_mfma_f32_16x16x32_bf16 v[136:139], v[56:59], v[16:19], v[136:139]
    ds_read_b64_tr_b16 v[84:85], v6 offset:16384
    v_mfma_f32_16x16x32_bf16 v[140:143], v[60:63], v[16:19], v[140:143]
    ds_read_b64_tr_b16 v[86:87], v6 offset:17408
    v_mfma_f32_16x16x32_bf16 v[144:147], v[32:35], v[20:23], v[144:147]
    ds_read_b64_tr_b16 v[88:89], v7 offset:16384
    v_mfma_f32_16x16x32_bf16 v[148:151], v[36:39], v[20:23], v[148:151]
    ds_read_b64_tr_b16 v[90:91], v7 offset:17408
    v_mfma_f32_16x16x32_bf16 v[152:155], v[40:43], v[20:23], v[152:155]
    ds_read_b64_tr_b16 v[92:93], v8 offset:16384
    v_mfma_f32_16x16x32_bf16 v[156:159], v[44:47], v[20:23], v[156:159]
    ds_read_b64_tr_b16 v[94:95], v8 offset:17408
    v_mfma_f32_16x16x32_bf16 v[160:163], v[48:51], v[20:23], v[160:163]
    ds_read_b64_tr_b16 v[96:97], v5 offset:24576
    v_mfma_f32_16x16x32_bf16 v[164:167], v[52:55], v[20:23], v[164:167]
    ds_read_b64_tr_b16 v[98:99], v5 offset:25600
    v_mfma_f32_16x16x32_bf16 v[168:171], v[56:59], v[20:23], v[168:171]
    ds_read_b64_tr_b16 v[100:101], v6 offset:24576
    v_mfma_f32_16x16x32_bf16 v[172:175], v[60:63], v[20:23], v[172:175]
    ds_read_b64_tr_b16 v[102:103], v6 offset:25600
    v_mfma_f32_16x16x32_bf16 v[176:179], v[32:35], v[24:27], v[176:179]
    ds_read_b64_tr_b16 v[104:105], v7 offset:24576
    v_mfma_f32_16x16x32_bf16 v[180:183], v[36:39], v[24:27], v[180:183]
    ds_read_b64_tr_b16 v[106:107], v7 offset:25600
    v_mfma_f32_16x16x32_bf16 v[184:187], v[40:43], v[24:27], v[184:187]
    ds_read_b64_tr_b16 v[108:109], v8 offset:24576
    v_mfma_f32_16x16x32_bf16 v[188:191], v[44:47], v[24:27], v[188:191]
    ds_read_b64_tr_b16 v[110:111], v8 offset:25600
    v_mfma_f32_16x16x32_bf16 v[192:195], v[48:51], v[24:27], v[192:195]
    v_mfma_f32_16x16x32_bf16 v[196:199], v[52:55], v[24:27], v[196:199]
    v_mfma_f32_16x16x32_bf16 v[200:203], v[56:59], v[24:27], v[200:203]
    v_mfma_f32_16x16x32_bf16 v[204:207], v[60:63], v[24:27], v[204:207]
    v_mfma_f32_16x16x32_bf16 v[208:211], v[32:35], v[28:31], v[208:211]
    v_mfma_f32_16x16x32_bf16 v[212:215], v[36:39], v[28:31], v[212:215]
    v_mfma_f32_16x16x32_bf16 v[216:219], v[40:43], v[28:31], v[216:219]
    v_mfma_f32_16x16x32_bf16 v[220:223], v[44:47], v[28:31], v[220:223]
    v_mfma_f32_16x16x32_bf16 v[224:227], v[48:51], v[28:31], v[224:227]
    v_mfma_f32_16x16x32_bf16 v[228:231], v[52:55], v[28:31], v[228:231]
    v_mfma_f32_16x16x32_bf16 v[232:235], v[56:59], v[28:31], v[232:235]
    v_mfma_f32_16x16x32_bf16 v[236:239], v[60:63], v[28:31], v[236:239]
    s_waitcnt lgkmcnt(0)
    s_barrier
    v_mfma_f32_16x16x32_bf16 v[112:115], v[80:83], v[64:67], v[112:115]
    ds_read_b128 v[16:19], v3 offset:0
    v_mfma_f32_16x16x32_bf16 v[116:119], v[84:87], v[64:67], v[116:119]
    ds_read_b128 v[20:23], v3 offset:2048
    v_mfma_f32_16x16x32_bf16 v[120:123], v[88:91], v[64:67], v[120:123]
    ds_read_b128 v[24:27], v3 offset:4096
    v_mfma_f32_16x16x32_bf16 v[124:127], v[92:95], v[64:67], v[124:127]
    ds_read_b128 v[28:31], v3 offset:6144
    v_mfma_f32_16x16x32_bf16 v[128:131], v[96:99], v[64:67], v[128:131]
    ds_read_b64_tr_b16 v[32:33], v5 offset:32768
    v_mfma_f32_16x16x32_bf16 v[132:135], v[100:103], v[64:67], v[132:135]
    ds_read_b64_tr_b16 v[34:35], v5 offset:33792
    v_mfma_f32_16x16x32_bf16 v[136:139], v[104:107], v[64:67], v[136:139]
    ds_read_b64_tr_b16 v[36:37], v6 offset:32768
    v_mfma_f32_16x16x32_bf16 v[140:143], v[108:111], v[64:67], v[140:143]
    ds_read_b64_tr_b16 v[38:39], v6 offset:33792
    v_mfma_f32_16x16x32_bf16 v[144:147], v[80:83], v[68:71], v[144:147]
    ds_read_b64_tr_b16 v[40:41], v7 offset:32768
    v_mfma_f32_16x16x32_bf16 v[148:151], v[84:87], v[68:71], v[148:151]
    ds_read_b64_tr_b16 v[42:43], v7 offset:33792
    v_mfma_f32_16x16x32_bf16 v[152:155], v[88:91], v[68:71], v[152:155]
    ds_read_b64_tr_b16 v[44:45], v8 offset:32768
    v_mfma_f32_16x16x32_bf16 v[156:159], v[92:95], v[68:71], v[156:159]
    ds_read_b64_tr_b16 v[46:47], v8 offset:33792
    v_mfma_f32_16x16x32_bf16 v[160:163], v[96:99], v[68:71], v[160:163]
    ds_read_b64_tr_b16 v[48:49], v5 offset:40960
    v_mfma_f32_16x16x32_bf16 v[164:167], v[100:103], v[68:71], v[164:167]
    ds_read_b64_tr_b16 v[50:51], v5 offset:41984
    v_mfma_f32_16x16x32_bf16 v[168:171], v[104:107], v[68:71], v[168:171]
    ds_read_b64_tr_b16 v[52:53], v6 offset:40960
    v_mfma_f32_16x16x32_bf16 v[172:175], v[108:111], v[68:71], v[172:175]
    ds_read_b64_tr_b16 v[54:55], v6 offset:41984
    v_mfma_f32_16x16x32_bf16 v[176:179], v[80:83], v[72:75], v[176:179]
    ds_read_b64_tr_b16 v[56:57], v7 offset:40960
    v_mfma_f32_16x16x32_bf16 v[180:183], v[84:87], v[72:75], v[180:183]
    ds_read_b64_tr_b16 v[58:59], v7 offset:41984
    v_mfma_f32_16x16x32_bf16 v[184:187], v[88:91], v[72:75], v[184:187]
    ds_read_b64_tr_b16 v[60:61], v8 offset:40960
    v_mfma_f32_16x16x32_bf16 v[188:191], v[92:95], v[72:75], v[188:191]
    ds_read_b64_tr_b16 v[62:63], v8 offset:41984
    v_mfma_f32_16x16x32_bf16 v[192:195], v[96:99], v[72:75], v[192:195]
    v_mfma_f32_16x16x32_bf16 v[196:199], v[100:103], v[72:75], v[196:199]
    v_mfma_f32_16x16x32_bf16 v[200:203], v[104:107], v[72:75], v[200:203]
    v_mfma_f32_16x16x32_bf16 v[204:207], v[108:111], v[72:75], v[204:207]
    v_mfma_f32_16x16x32_bf16 v[208:211], v[80:83], v[76:79], v[208:211]
    v_mfma_f32_16x16x32_bf16 v[212:215], v[84:87], v[76:79], v[212:215]
    v_mfma_f32_16x16x32_bf16 v[216:219], v[88:91], v[76:79], v[216:219]
    v_mfma_f32_16x16x32_bf16 v[220:223], v[92:95], v[76:79], v[220:223]
    v_mfma_f32_16x16x32_bf16 v[224:227], v[96:99], v[76:79], v[224:227]
    v_mfma_f32_16x16x32_bf16 v[228:231], v[100:103], v[76:79], v[228:231]
    v_mfma_f32_16x16x32_bf16 v[232:235], v[104:107], v[76:79], v[232:235]
    v_mfma_f32_16x16x32_bf16 v[236:239], v[108:111], v[76:79], v[236:239]
    s_waitcnt lgkmcnt(0)
    s_barrier
    v_mfma_f32_16x16x32_bf16 v[112:115], v[32:35], v[16:19], v[112:115]
    ds_read_b128 v[64:67], v4 offset:0
    v_mfma_f32_16x16x32_bf16 v[116:119], v[36:39], v[16:19], v[116:119]
    ds_read_b128 v[68:71], v4 offset:2048
    v_mfma_f32_16x16x32_bf16 v[120:123], v[40:43], v[16:19], v[120:123]
    ds_read_b128 v[72:75], v4 offset:4096
    v_mfma_f32_16x16x32_bf16 v[124:127], v[44:47], v[16:19], v[124:127]
    ds_read_b128 v[76:79], v4 offset:6144
    v_mfma_f32_16x16x32_bf16 v[128:131], v[48:51], v[16:19], v[128:131]
    ds_read_b64_tr_b16 v[80:81], v5 offset:49152
    v_mfma_f32_16x16x32_bf16 v[132:135], v[52:55], v[16:19], v[132:135]
    ds_read_b64_tr_b16 v[82:83], v5 offset:50176
    v_mfma_f32_16x16x32_bf16 v[136:139], v[56:59], v[16:19], v[136:139]
    ds_read_b64_tr_b16 v[84:85], v6 offset:49152
    v_mfma_f32_16x16x32_bf16 v[140:143], v[60:63], v[16:19], v[140:143]
    ds_read_b64_tr_b16 v[86:87], v6 offset:50176
    v_mfma_f32_16x16x32_bf16 v[144:147], v[32:35], v[20:23], v[144:147]
    ds_read_b64_tr_b16 v[88:89], v7 offset:49152
    v_mfma_f32_16x16x32_bf16 v[148:151], v[36:39], v[20:23], v[148:151]
    ds_read_b64_tr_b16 v[90:91], v7 offset:50176
    v_mfma_f32_16x16x32_bf16 v[152:155], v[40:43], v[20:23], v[152:155]
    ds_read_b64_tr_b16 v[92:93], v8 offset:49152
    v_mfma_f32_16x16x32_bf16 v[156:159], v[44:47], v[20:23], v[156:159]
    ds_read_b64_tr_b16 v[94:95], v8 offset:50176
    v_mfma_f32_16x16x32_bf16 v[160:163], v[48:51], v[20:23], v[160:163]
    ds_read_b64_tr_b16 v[96:97], v5 offset:57344
    v_mfma_f32_16x16x32_bf16 v[164:167], v[52:55], v[20:23], v[164:167]
    ds_read_b64_tr_b16 v[98:99], v5 offset:58368
    v_mfma_f32_16x16x32_bf16 v[168:171], v[56:59], v[20:23], v[168:171]
    ds_read_b64_tr_b16 v[100:101], v6 offset:57344
    v_mfma_f32_16x16x32_bf16 v[172:175], v[60:63], v[20:23], v[172:175]
    ds_read_b64_tr_b16 v[102:103], v6 offset:58368
    v_mfma_f32_16x16x32_bf16 v[176:179], v[32:35], v[24:27], v[176:179]
    ds_read_b64_tr_b16 v[104:105], v7 offset:57344
    v_mfma_f32_16x16x32_bf16 v[180:183], v[36:39], v[24:27], v[180:183]
    ds_read_b64_tr_b16 v[106:107], v7 offset:58368
    v_mfma_f32_16x16x32_bf16 v[184:187], v[40:43], v[24:27], v[184:187]
    ds_read_b64_tr_b16 v[108:109], v8 offset:57344
    v_mfma_f32_16x16x32_bf16 v[188:191], v[44:47], v[24:27], v[188:191]
    ds_read_b64_tr_b16 v[110:111], v8 offset:58368
    v_mfma_f32_16x16x32_bf16 v[192:195], v[48:51], v[24:27], v[192:195]
    v_mfma_f32_16x16x32_bf16 v[196:199], v[52:55], v[24:27], v[196:199]
    v_mfma_f32_16x16x32_bf16 v[200:203], v[56:59], v[24:27], v[200:203]
    v_mfma_f32_16x16x32_bf16 v[204:207], v[60:63], v[24:27], v[204:207]
    v_mfma_f32_16x16x32_bf16 v[208:211], v[32:35], v[28:31], v[208:211]
    v_mfma_f32_16x16x32_bf16 v[212:215], v[36:39], v[28:31], v[212:215]
    v_mfma_f32_16x16x32_bf16 v[216:219], v[40:43], v[28:31], v[216:219]
    v_mfma_f32_16x16x32_bf16 v[220:223], v[44:47], v[28:31], v[220:223]
    v_mfma_f32_16x16x32_bf16 v[224:227], v[48:51], v[28:31], v[224:227]
    v_mfma_f32_16x16x32_bf16 v[228:231], v[52:55], v[28:31], v[228:231]
    v_mfma_f32_16x16x32_bf16 v[232:235], v[56:59], v[28:31], v[232:235]
    v_mfma_f32_16x16x32_bf16 v[236:239], v[60:63], v[28:31], v[236:239]
    s_waitcnt lgkmcnt(0)
    s_barrier
    v_mfma_f32_16x16x32_bf16 v[112:115], v[80:83], v[64:67], v[112:115]
    ds_read_b128 v[16:19], v3 offset:16384
    v_mfma_f32_16x16x32_bf16 v[116:119], v[84:87], v[64:67], v[116:119]
    ds_read_b128 v[20:23], v3 offset:18432
    v_mfma_f32_16x16x32_bf16 v[120:123], v[88:91], v[64:67], v[120:123]
    ds_read_b128 v[24:27], v3 offset:20480
    v_mfma_f32_16x16x32_bf16 v[124:127], v[92:95], v[64:67], v[124:127]
    ds_read_b128 v[28:31], v3 offset:22528
    v_mfma_f32_16x16x32_bf16 v[128:131], v[96:99], v[64:67], v[128:131]
    ds_read_b64_tr_b16 v[32:33], v5 offset:0
    v_mfma_f32_16x16x32_bf16 v[132:135], v[100:103], v[64:67], v[132:135]
    ds_read_b64_tr_b16 v[34:35], v5 offset:1024
    v_mfma_f32_16x16x32_bf16 v[136:139], v[104:107], v[64:67], v[136:139]
    ds_read_b64_tr_b16 v[36:37], v6 offset:0
    v_mfma_f32_16x16x32_bf16 v[140:143], v[108:111], v[64:67], v[140:143]
    ds_read_b64_tr_b16 v[38:39], v6 offset:1024
    v_mfma_f32_16x16x32_bf16 v[144:147], v[80:83], v[68:71], v[144:147]
    ds_read_b64_tr_b16 v[40:41], v7 offset:0
    v_mfma_f32_16x16x32_bf16 v[148:151], v[84:87], v[68:71], v[148:151]
    ds_read_b64_tr_b16 v[42:43], v7 offset:1024
    v_mfma_f32_16x16x32_bf16 v[152:155], v[88:91], v[68:71], v[152:155]
    ds_read_b64_tr_b16 v[44:45], v8 offset:0
    v_mfma_f32_16x16x32_bf16 v[156:159], v[92:95], v[68:71], v[156:159]
    ds_read_b64_tr_b16 v[46:47], v8 offset:1024
    v_mfma_f32_16x16x32_bf16 v[160:163], v[96:99], v[68:71], v[160:163]
    ds_read_b64_tr_b16 v[48:49], v5 offset:8192
    v_mfma_f32_16x16x32_bf16 v[164:167], v[100:103], v[68:71], v[164:167]
    ds_read_b64_tr_b16 v[50:51], v5 offset:9216
    v_mfma_f32_16x16x32_bf16 v[168:171], v[104:107], v[68:71], v[168:171]
    ds_read_b64_tr_b16 v[52:53], v6 offset:8192
    v_mfma_f32_16x16x32_bf16 v[172:175], v[108:111], v[68:71], v[172:175]
    ds_read_b64_tr_b16 v[54:55], v6 offset:9216
    v_mfma_f32_16x16x32_bf16 v[176:179], v[80:83], v[72:75], v[176:179]
    ds_read_b64_tr_b16 v[56:57], v7 offset:8192
    v_mfma_f32_16x16x32_bf16 v[180:183], v[84:87], v[72:75], v[180:183]
    ds_read_b64_tr_b16 v[58:59], v7 offset:9216
    v_mfma_f32_16x16x32_bf16 v[184:187], v[88:91], v[72:75], v[184:187]
    ds_read_b64_tr_b16 v[60:61], v8 offset:8192
    v_mfma_f32_16x16x32_bf16 v[188:191], v[92:95], v[72:75], v[188:191]
    ds_read_b64_tr_b16 v[62:63], v8 offset:9216
    v_mfma_f32_16x16x32_bf16 v[192:195], v[96:99], v[72:75], v[192:195]
    v_mfma_f32_16x16x32_bf16 v[196:199], v[100:103], v[72:75], v[196:199]
    v_mfma_f32_16x16x32_bf16 v[200:203], v[104:107], v[72:75], v[200:203]
    v_mfma_f32_16x16x32_bf16 v[204:207], v[108:111], v[72:75], v[204:207]
    v_mfma_f32_16x16x32_bf16 v[208:211], v[80:83], v[76:79], v[208:211]
    v_mfma_f32_16x16x32_bf16 v[212:215], v[84:87], v[76:79], v[212:215]
    v_mfma_f32_16x16x32_bf16 v[216:219], v[88:91], v[76:79], v[216:219]
    v_mfma_f32_16x16x32_bf16 v[220:223], v[92:95], v[76:79], v[220:223]
    v_mfma_f32_16x16x32_bf16 v[224:227], v[96:99], v[76:79], v[224:227]
    v_mfma_f32_16x16x32_bf16 v[228:231], v[100:103], v[76:79], v[228:231]
    v_mfma_f32_16x16x32_bf16 v[232:235], v[104:107], v[76:79], v[232:235]
    v_mfma_f32_16x16x32_bf16 v[236:239], v[108:111], v[76:79], v[236:239]
    s_waitcnt lgkmcnt(0)
    s_barrier
    v_mfma_f32_16x16x32_bf16 v[112:115], v[32:35], v[16:19], v[112:115]
    ds_read_b128 v[64:67], v4 offset:16384
    v_mfma_f32_16x16x32_bf16 v[116:119], v[36:39], v[16:19], v[116:119]
    ds_read_b128 v[68:71], v4 offset:18432
    v_mfma_f32_16x16x32_bf16 v[120:123], v[40:43], v[16:19], v[120:123]
    ds_read_b128 v[72:75], v4 offset:20480
    v_mfma_f32_16x16x32_bf16 v[124:127], v[44:47], v[16:19], v[124:127]
    ds_read_b128 v[76:79], v4 offset:22528
    v_mfma_f32_16x16x32_bf16 v[128:131], v[48:51], v[16:19], v[128:131]
    ds_read_b64_tr_b16 v[80:81], v5 offset:16384
    v_mfma_f32_16x16x32_bf16 v[132:135], v[52:55], v[16:19], v[132:135]
    ds_read_b64_tr_b16 v[82:83], v5 offset:17408
    v_mfma_f32_16x16x32_bf16 v[136:139], v[56:59], v[16:19], v[136:139]
    ds_read_b64_tr_b16 v[84:85], v6 offset:16384
    v_mfma_f32_16x16x32_bf16 v[140:143], v[60:63], v[16:19], v[140:143]
    ds_read_b64_tr_b16 v[86:87], v6 offset:17408
    v_mfma_f32_16x16x32_bf16 v[144:147], v[32:35], v[20:23], v[144:147]
    ds_read_b64_tr_b16 v[88:89], v7 offset:16384
    v_mfma_f32_16x16x32_bf16 v[148:151], v[36:39], v[20:23], v[148:151]
    ds_read_b64_tr_b16 v[90:91], v7 offset:17408
    v_mfma_f32_16x16x32_bf16 v[152:155], v[40:43], v[20:23], v[152:155]
    ds_read_b64_tr_b16 v[92:93], v8 offset:16384
    v_mfma_f32_16x16x32_bf16 v[156:159], v[44:47], v[20:23], v[156:159]
    ds_read_b64_tr_b16 v[94:95], v8 offset:17408
    v_mfma_f32_16x16x32_bf16 v[160:163], v[48:51], v[20:23], v[160:163]
    ds_read_b64_tr_b16 v[96:97], v5 offset:24576
    v_mfma_f32_16x16x32_bf16 v[164:167], v[52:55], v[20:23], v[164:167]
    ds_read_b64_tr_b16 v[98:99], v5 offset:25600
    v_mfma_f32_16x16x32_bf16 v[168:171], v[56:59], v[20:23], v[168:171]
    ds_read_b64_tr_b16 v[100:101], v6 offset:24576
    v_mfma_f32_16x16x32_bf16 v[172:175], v[60:63], v[20:23], v[172:175]
    ds_read_b64_tr_b16 v[102:103], v6 offset:25600
    v_mfma_f32_16x16x32_bf16 v[176:179], v[32:35], v[24:27], v[176:179]
    ds_read_b64_tr_b16 v[104:105], v7 offset:24576
    v_mfma_f32_16x16x32_bf16 v[180:183], v[36:39], v[24:27], v[180:183]
    ds_read_b64_tr_b16 v[106:107], v7 offset:25600
    v_mfma_f32_16x16x32_bf16 v[184:187], v[40:43], v[24:27], v[184:187]
    ds_read_b64_tr_b16 v[108:109], v8 offset:24576
    v_mfma_f32_16x16x32_bf16 v[188:191], v[44:47], v[24:27], v[188:191]
    ds_read_b64_tr_b16 v[110:111], v8 offset:25600
    v_mfma_f32_16x16x32_bf16 v[192:195], v[48:51], v[24:27], v[192:195]
    v_mfma_f32_16x16x32_bf16 v[196:199], v[52:55], v[24:27], v[196:199]
    v_mfma_f32_16x16x32_bf16 v[200:203], v[56:59], v[24:27], v[200:203]
    v_mfma_f32_16x16x32_bf16 v[204:207], v[60:63], v[24:27], v[204:207]
    v_mfma_f32_16x16x32_bf16 v[208:211], v[32:35], v[28:31], v[208:211]
    v_mfma_f32_16x16x32_bf16 v[212:215], v[36:39], v[28:31], v[212:215]
    v_mfma_f32_16x16x32_bf16 v[216:219], v[40:43], v[28:31], v[216:219]
    v_mfma_f32_16x16x32_bf16 v[220:223], v[44:47], v[28:31], v[220:223]
    v_mfma_f32_16x16x32_bf16 v[224:227], v[48:51], v[28:31], v[224:227]
    v_mfma_f32_16x16x32_bf16 v[228:231], v[52:55], v[28:31], v[228:231]
    v_mfma_f32_16x16x32_bf16 v[232:235], v[56:59], v[28:31], v[232:235]
    v_mfma_f32_16x16x32_bf16 v[236:239], v[60:63], v[28:31], v[236:239]
    s_waitcnt lgkmcnt(0)
    s_barrier
    v_mfma_f32_16x16x32_bf16 v[112:115], v[80:83], v[64:67], v[112:115]
    ds_read_b128 v[16:19], v3 offset:32768
    v_mfma_f32_16x16x32_bf16 v[116:119], v[84:87], v[64:67], v[116:119]
    ds_read_b128 v[20:23], v3 offset:34816
    v_mfma_f32_16x16x32_bf16 v[120:123], v[88:91], v[64:67], v[120:123]
    ds_read_b128 v[24:27], v3 offset:36864
    v_mfma_f32_16x16x32_bf16 v[124:127], v[92:95], v[64:67], v[124:127]
    ds_read_b128 v[28:31], v3 offset:38912
    v_mfma_f32_16x16x32_bf16 v[128:131], v[96:99], v[64:67], v[128:131]
    ds_read_b64_tr_b16 v[32:33], v5 offset:32768
    v_mfma_f32_16x16x32_bf16 v[132:135], v[100:103], v[64:67], v[132:135]
    ds_read_b64_tr_b16 v[34:35], v5 offset:33792
    v_mfma_f32_16x16x32_bf16 v[136:139], v[104:107], v[64:67], v[136:139]
    ds_read_b64_tr_b16 v[36:37], v6 offset:32768
    v_mfma_f32_16x16x32_bf16 v[140:143], v[108:111], v[64:67], v[140:143]
    ds_read_b64_tr_b16 v[38:39], v6 offset:33792
    v_mfma_f32_16x16x32_bf16 v[144:147], v[80:83], v[68:71], v[144:147]
    ds_read_b64_tr_b16 v[40:41], v7 offset:32768
    v_mfma_f32_16x16x32_bf16 v[148:151], v[84:87], v[68:71], v[148:151]
    ds_read_b64_tr_b16 v[42:43], v7 offset:33792
    v_mfma_f32_16x16x32_bf16 v[152:155], v[88:91], v[68:71], v[152:155]
    ds_read_b64_tr_b16 v[44:45], v8 offset:32768
    v_mfma_f32_16x16x32_bf16 v[156:159], v[92:95], v[68:71], v[156:159]
    ds_read_b64_tr_b16 v[46:47], v8 offset:33792
    v_mfma_f32_16x16x32_bf16 v[160:163], v[96:99], v[68:71], v[160:163]
    ds_read_b64_tr_b16 v[48:49], v5 offset:40960
    v_mfma_f32_16x16x32_bf16 v[164:167], v[100:103], v[68:71], v[164:167]
    ds_read_b64_tr_b16 v[50:51], v5 offset:41984
    v_mfma_f32_16x16x32_bf16 v[168:171], v[104:107], v[68:71], v[168:171]
    ds_read_b64_tr_b16 v[52:53], v6 offset:40960
    v_mfma_f32_16x16x32_bf16 v[172:175], v[108:111], v[68:71], v[172:175]
    ds_read_b64_tr_b16 v[54:55], v6 offset:41984
    v_mfma_f32_16x16x32_bf16 v[176:179], v[80:83], v[72:75], v[176:179]
    ds_read_b64_tr_b16 v[56:57], v7 offset:40960
    v_mfma_f32_16x16x32_bf16 v[180:183], v[84:87], v[72:75], v[180:183]
    ds_read_b64_tr_b16 v[58:59], v7 offset:41984
    v_mfma_f32_16x16x32_bf16 v[184:187], v[88:91], v[72:75], v[184:187]
    ds_read_b64_tr_b16 v[60:61], v8 offset:40960
    v_mfma_f32_16x16x32_bf16 v[188:191], v[92:95], v[72:75], v[188:191]
    ds_read_b64_tr_b16 v[62:63], v8 offset:41984
    v_mfma_f32_16x16x32_bf16 v[192:195], v[96:99], v[72:75], v[192:195]
    v_mfma_f32_16x16x32_bf16 v[196:199], v[100:103], v[72:75], v[196:199]
    v_mfma_f32_16x16x32_bf16 v[200:203], v[104:107], v[72:75], v[200:203]
    v_mfma_f32_16x16x32_bf16 v[204:207], v[108:111], v[72:75], v[204:207]
    v_mfma_f32_16x16x32_bf16 v[208:211], v[80:83], v[76:79], v[208:211]
    v_mfma_f32_16x16x32_bf16 v[212:215], v[84:87], v[76:79], v[212:215]
    v_mfma_f32_16x16x32_bf16 v[216:219], v[88:91], v[76:79], v[216:219]
    v_mfma_f32_16x16x32_bf16 v[220:223], v[92:95], v[76:79], v[220:223]
    v_mfma_f32_16x16x32_bf16 v[224:227], v[96:99], v[76:79], v[224:227]
    v_mfma_f32_16x16x32_bf16 v[228:231], v[100:103], v[76:79], v[228:231]
    v_mfma_f32_16x16x32_bf16 v[232:235], v[104:107], v[76:79], v[232:235]
    v_mfma_f32_16x16x32_bf16 v[236:239], v[108:111], v[76:79], v[236:239]
    s_waitcnt lgkmcnt(0)
    s_barrier
    v_mfma_f32_16x16x32_bf16 v[112:115], v[32:35], v[16:19], v[112:115]
    ds_read_b128 v[64:67], v4 offset:32768
    v_mfma_f32_16x16x32_bf16 v[116:119], v[36:39], v[16:19], v[116:119]
    ds_read_b128 v[68:71], v4 offset:34816
    v_mfma_f32_16x16x32_bf16 v[120:123], v[40:43], v[16:19], v[120:123]
    ds_read_b128 v[72:75], v4 offset:36864
    v_mfma_f32_16x16x32_bf16 v[124:127], v[44:47], v[16:19], v[124:127]
    ds_read_b128 v[76:79], v4 offset:38912
    v_mfma_f32_16x16x32_bf16 v[128:131], v[48:51], v[16:19], v[128:131]
    ds_read_b64_tr_b16 v[80:81], v5 offset:49152
    v_mfma_f32_16x16x32_bf16 v[132:135], v[52:55], v[16:19], v[132:135]
    ds_read_b64_tr_b16 v[82:83], v5 offset:50176
    v_mfma_f32_16x16x32_bf16 v[136:139], v[56:59], v[16:19], v[136:139]
    ds_read_b64_tr_b16 v[84:85], v6 offset:49152
    v_mfma_f32_16x16x32_bf16 v[140:143], v[60:63], v[16:19], v[140:143]
    ds_read_b64_tr_b16 v[86:87], v6 offset:50176
    v_mfma_f32_16x16x32_bf16 v[144:147], v[32:35], v[20:23], v[144:147]
    ds_read_b64_tr_b16 v[88:89], v7 offset:49152
    v_mfma_f32_16x16x32_bf16 v[148:151], v[36:39], v[20:23], v[148:151]
    ds_read_b64_tr_b16 v[90:91], v7 offset:50176
    v_mfma_f32_16x16x32_bf16 v[152:155], v[40:43], v[20:23], v[152:155]
    ds_read_b64_tr_b16 v[92:93], v8 offset:49152
    v_mfma_f32_16x16x32_bf16 v[156:159], v[44:47], v[20:23], v[156:159]
    ds_read_b64_tr_b16 v[94:95], v8 offset:50176
    v_mfma_f32_16x16x32_bf16 v[160:163], v[48:51], v[20:23], v[160:163]
    ds_read_b64_tr_b16 v[96:97], v5 offset:57344
    v_mfma_f32_16x16x32_bf16 v[164:167], v[52:55], v[20:23], v[164:167]
    ds_read_b64_tr_b16 v[98:99], v5 offset:58368
    v_mfma_f32_16x16x32_bf16 v[168:171], v[56:59], v[20:23], v[168:171]
    ds_read_b64_tr_b16 v[100:101], v6 offset:57344
    v_mfma_f32_16x16x32_bf16 v[172:175], v[60:63], v[20:23], v[172:175]
    ds_read_b64_tr_b16 v[102:103], v6 offset:58368
    v_mfma_f32_16x16x32_bf16 v[176:179], v[32:35], v[24:27], v[176:179]
    ds_read_b64_tr_b16 v[104:105], v7 offset:57344
    v_mfma_f32_16x16x32_bf16 v[180:183], v[36:39], v[24:27], v[180:183]
    ds_read_b64_tr_b16 v[106:107], v7 offset:58368
    v_mfma_f32_16x16x32_bf16 v[184:187], v[40:43], v[24:27], v[184:187]
    ds_read_b64_tr_b16 v[108:109], v8 offset:57344
    v_mfma_f32_16x16x32_bf16 v[188:191], v[44:47], v[24:27], v[188:191]
    ds_read_b64_tr_b16 v[110:111], v8 offset:58368
    v_mfma_f32_16x16x32_bf16 v[192:195], v[48:51], v[24:27], v[192:195]
    v_mfma_f32_16x16x32_bf16 v[196:199], v[52:55], v[24:27], v[196:199]
    v_mfma_f32_16x16x32_bf16 v[200:203], v[56:59], v[24:27], v[200:203]
    v_mfma_f32_16x16x32_bf16 v[204:207], v[60:63], v[24:27], v[204:207]
    v_mfma_f32_16x16x32_bf16 v[208:211], v[32:35], v[28:31], v[208:211]
    v_mfma_f32_16x16x32_bf16 v[212:215], v[36:39], v[28:31], v[212:215]
    v_mfma_f32_16x16x32_bf16 v[216:219], v[40:43], v[28:31], v[216:219]
    v_mfma_f32_16x16x32_bf16 v[220:223], v[44:47], v[28:31], v[220:223]
    v_mfma_f32_16x16x32_bf16 v[224:227], v[48:51], v[28:31], v[224:227]
    v_mfma_f32_16x16x32_bf16 v[228:231], v[52:55], v[28:31], v[228:231]
    v_mfma_f32_16x16x32_bf16 v[232:235], v[56:59], v[28:31], v[232:235]
    v_mfma_f32_16x16x32_bf16 v[236:239], v[60:63], v[28:31], v[236:239]
    s_waitcnt lgkmcnt(0)
    s_barrier
    v_mfma_f32_16x16x32_bf16 v[112:115], v[80:83], v[64:67], v[112:115]
    ds_read_b128 v[16:19], v3 offset:0
    v_mfma_f32_16x16x32_bf16 v[116:119], v[84:87], v[64:67], v[116:119]
    ds_read_b128 v[20:23], v3 offset:2048
    v_mfma_f32_16x16x32_bf16 v[120:123], v[88:91], v[64:67], v[120:123]
    ds_read_b128 v[24:27], v3 offset:4096
    v_mfma_f32_16x16x32_bf16 v[124:127], v[92:95], v[64:67], v[124:127]
    ds_read_b128 v[28:31], v3 offset:6144
    v_mfma_f32_16x16x32_bf16 v[128:131], v[96:99], v[64:67], v[128:131]
    ds_read_b64_tr_b16 v[32:33], v5 offset:0
    v_mfma_f32_16x16x32_bf16 v[132:135], v[100:103], v[64:67], v[132:135]
    ds_read_b64_tr_b16 v[34:35], v5 offset:1024
    v_mfma_f32_16x16x32_bf16 v[136:139], v[104:107], v[64:67], v[136:139]
    ds_read_b64_tr_b16 v[36:37], v6 offset:0
    v_mfma_f32_16x16x32_bf16 v[140:143], v[108:111], v[64:67], v[140:143]
    ds_read_b64_tr_b16 v[38:39], v6 offset:1024
    v_mfma_f32_16x16x32_bf16 v[144:147], v[80:83], v[68:71], v[144:147]
    ds_read_b64_tr_b16 v[40:41], v7 offset:0
    v_mfma_f32_16x16x32_bf16 v[148:151], v[84:87], v[68:71], v[148:151]
    ds_read_b64_tr_b16 v[42:43], v7 offset:1024
    v_mfma_f32_16x16x32_bf16 v[152:155], v[88:91], v[68:71], v[152:155]
    ds_read_b64_tr_b16 v[44:45], v8 offset:0
    v_mfma_f32_16x16x32_bf16 v[156:159], v[92:95], v[68:71], v[156:159]
    ds_read_b64_tr_b16 v[46:47], v8 offset:1024
    v_mfma_f32_16x16x32_bf16 v[160:163], v[96:99], v[68:71], v[160:163]
    ds_read_b64_tr_b16 v[48:49], v5 offset:8192
    v_mfma_f32_16x16x32_bf16 v[164:167], v[100:103], v[68:71], v[164:167]
    ds_read_b64_tr_b16 v[50:51], v5 offset:9216
    v_mfma_f32_16x16x32_bf16 v[168:171], v[104:107], v[68:71], v[168:171]
    ds_read_b64_tr_b16 v[52:53], v6 offset:8192
    v_mfma_f32_16x16x32_bf16 v[172:175], v[108:111], v[68:71], v[172:175]
    ds_read_b64_tr_b16 v[54:55], v6 offset:9216
    v_mfma_f32_16x16x32_bf16 v[176:179], v[80:83], v[72:75], v[176:179]
    ds_read_b64_tr_b16 v[56:57], v7 offset:8192
    v_mfma_f32_16x16x32_bf16 v[180:183], v[84:87], v[72:75], v[180:183]
    ds_read_b64_tr_b16 v[58:59], v7 offset:9216
    v_mfma_f32_16x16x32_bf16 v[184:187], v[88:91], v[72:75], v[184:187]
    ds_read_b64_tr_b16 v[60:61], v8 offset:8192
    v_mfma_f32_16x16x32_bf16 v[188:191], v[92:95], v[72:75], v[188:191]
    ds_read_b64_tr_b16 v[62:63], v8 offset:9216
    v_mfma_f32_16x16x32_bf16 v[192:195], v[96:99], v[72:75], v[192:195]
    v_mfma_f32_16x16x32_bf16 v[196:199], v[100:103], v[72:75], v[196:199]
    v_mfma_f32_16x16x32_bf16 v[200:203], v[104:107], v[72:75], v[200:203]
    v_mfma_f32_16x16x32_bf16 v[204:207], v[108:111], v[72:75], v[204:207]
    v_mfma_f32_16x16x32_bf16 v[208:211], v[80:83], v[76:79], v[208:211]
    v_mfma_f32_16x16x32_bf16 v[212:215], v[84:87], v[76:79], v[212:215]
    v_mfma_f32_16x16x32_bf16 v[216:219], v[88:91], v[76:79], v[216:219]
    v_mfma_f32_16x16x32_bf16 v[220:223], v[92:95], v[76:79], v[220:223]
    v_mfma_f32_16x16x32_bf16 v[224:227], v[96:99], v[76:79], v[224:227]
    v_mfma_f32_16x16x32_bf16 v[228:231], v[100:103], v[76:79], v[228:231]
    v_mfma_f32_16x16x32_bf16 v[232:235], v[104:107], v[76:79], v[232:235]
    v_mfma_f32_16x16x32_bf16 v[236:239], v[108:111], v[76:79], v[236:239]
    s_waitcnt lgkmcnt(0)
    s_barrier
    v_mfma_f32_16x16x32_bf16 v[112:115], v[32:35], v[16:19], v[112:115]
    ds_read_b128 v[64:67], v4 offset:0
    v_mfma_f32_16x16x32_bf16 v[116:119], v[36:39], v[16:19], v[116:119]
    ds_read_b128 v[68:71], v4 offset:2048
    v_mfma_f32_16x16x32_bf16 v[120:123], v[40:43], v[16:19], v[120:123]
    ds_read_b128 v[72:75], v4 offset:4096
    v_mfma_f32_16x16x32_bf16 v[124:127], v[44:47], v[16:19], v[124:127]
    ds_read_b128 v[76:79], v4 offset:6144
    v_mfma_f32_16x16x32_bf16 v[128:131], v[48:51], v[16:19], v[128:131]
    ds_read_b64_tr_b16 v[80:81], v5 offset:16384
    v_mfma_f32_16x16x32_bf16 v[132:135], v[52:55], v[16:19], v[132:135]
    ds_read_b64_tr_b16 v[82:83], v5 offset:17408
    v_mfma_f32_16x16x32_bf16 v[136:139], v[56:59], v[16:19], v[136:139]
    ds_read_b64_tr_b16 v[84:85], v6 offset:16384
    v_mfma_f32_16x16x32_bf16 v[140:143], v[60:63], v[16:19], v[140:143]
    ds_read_b64_tr_b16 v[86:87], v6 offset:17408
    v_mfma_f32_16x16x32_bf16 v[144:147], v[32:35], v[20:23], v[144:147]
    ds_read_b64_tr_b16 v[88:89], v7 offset:16384
    v_mfma_f32_16x16x32_bf16 v[148:151], v[36:39], v[20:23], v[148:151]
    ds_read_b64_tr_b16 v[90:91], v7 offset:17408
    v_mfma_f32_16x16x32_bf16 v[152:155], v[40:43], v[20:23], v[152:155]
    ds_read_b64_tr_b16 v[92:93], v8 offset:16384
    v_mfma_f32_16x16x32_bf16 v[156:159], v[44:47], v[20:23], v[156:159]
    ds_read_b64_tr_b16 v[94:95], v8 offset:17408
    v_mfma_f32_16x16x32_bf16 v[160:163], v[48:51], v[20:23], v[160:163]
    ds_read_b64_tr_b16 v[96:97], v5 offset:24576
    v_mfma_f32_16x16x32_bf16 v[164:167], v[52:55], v[20:23], v[164:167]
    ds_read_b64_tr_b16 v[98:99], v5 offset:25600
    v_mfma_f32_16x16x32_bf16 v[168:171], v[56:59], v[20:23], v[168:171]
    ds_read_b64_tr_b16 v[100:101], v6 offset:24576
    v_mfma_f32_16x16x32_bf16 v[172:175], v[60:63], v[20:23], v[172:175]
    ds_read_b64_tr_b16 v[102:103], v6 offset:25600
    v_mfma_f32_16x16x32_bf16 v[176:179], v[32:35], v[24:27], v[176:179]
    ds_read_b64_tr_b16 v[104:105], v7 offset:24576
    v_mfma_f32_16x16x32_bf16 v[180:183], v[36:39], v[24:27], v[180:183]
    ds_read_b64_tr_b16 v[106:107], v7 offset:25600
    v_mfma_f32_16x16x32_bf16 v[184:187], v[40:43], v[24:27], v[184:187]
    ds_read_b64_tr_b16 v[108:109], v8 offset:24576
    v_mfma_f32_16x16x32_bf16 v[188:191], v[44:47], v[24:27], v[188:191]
    ds_read_b64_tr_b16 v[110:111], v8 offset:25600
    v_mfma_f32_16x16x32_bf16 v[192:195], v[48:51], v[24:27], v[192:195]
    v_mfma_f32_16x16x32_bf16 v[196:199], v[52:55], v[24:27], v[196:199]
    v_mfma_f32_16x16x32_bf16 v[200:203], v[56:59], v[24:27], v[200:203]
    v_mfma_f32_16x16x32_bf16 v[204:207], v[60:63], v[24:27], v[204:207]
    v_mfma_f32_16x16x32_bf16 v[208:211], v[32:35], v[28:31], v[208:211]
    v_mfma_f32_16x16x32_bf16 v[212:215], v[36:39], v[28:31], v[212:215]
    v_mfma_f32_16x16x32_bf16 v[216:219], v[40:43], v[28:31], v[216:219]
    v_mfma_f32_16x16x32_bf16 v[220:223], v[44:47], v[28:31], v[220:223]
    v_mfma_f32_16x16x32_bf16 v[224:227], v[48:51], v[28:31], v[224:227]
    v_mfma_f32_16x16x32_bf16 v[228:231], v[52:55], v[28:31], v[228:231]
    v_mfma_f32_16x16x32_bf16 v[232:235], v[56:59], v[28:31], v[232:235]
    v_mfma_f32_16x16x32_bf16 v[236:239], v[60:63], v[28:31], v[236:239]
    s_waitcnt lgkmcnt(0)
    s_barrier
    v_mfma_f32_16x16x32_bf16 v[112:115], v[80:83], v[64:67], v[112:115]
    ds_read_b128 v[16:19], v3 offset:16384
    v_mfma_f32_16x16x32_bf16 v[116:119], v[84:87], v[64:67], v[116:119]
    ds_read_b128 v[20:23], v3 offset:18432
    v_mfma_f32_16x16x32_bf16 v[120:123], v[88:91], v[64:67], v[120:123]
    ds_read_b128 v[24:27], v3 offset:20480
    v_mfma_f32_16x16x32_bf16 v[124:127], v[92:95], v[64:67], v[124:127]
    ds_read_b128 v[28:31], v3 offset:22528
    v_mfma_f32_16x16x32_bf16 v[128:131], v[96:99], v[64:67], v[128:131]
    ds_read_b64_tr_b16 v[32:33], v5 offset:32768
    v_mfma_f32_16x16x32_bf16 v[132:135], v[100:103], v[64:67], v[132:135]
    ds_read_b64_tr_b16 v[34:35], v5 offset:33792
    v_mfma_f32_16x16x32_bf16 v[136:139], v[104:107], v[64:67], v[136:139]
    ds_read_b64_tr_b16 v[36:37], v6 offset:32768
    v_mfma_f32_16x16x32_bf16 v[140:143], v[108:111], v[64:67], v[140:143]
    ds_read_b64_tr_b16 v[38:39], v6 offset:33792
    v_mfma_f32_16x16x32_bf16 v[144:147], v[80:83], v[68:71], v[144:147]
    ds_read_b64_tr_b16 v[40:41], v7 offset:32768
    v_mfma_f32_16x16x32_bf16 v[148:151], v[84:87], v[68:71], v[148:151]
    ds_read_b64_tr_b16 v[42:43], v7 offset:33792
    v_mfma_f32_16x16x32_bf16 v[152:155], v[88:91], v[68:71], v[152:155]
    ds_read_b64_tr_b16 v[44:45], v8 offset:32768
    v_mfma_f32_16x16x32_bf16 v[156:159], v[92:95], v[68:71], v[156:159]
    ds_read_b64_tr_b16 v[46:47], v8 offset:33792
    v_mfma_f32_16x16x32_bf16 v[160:163], v[96:99], v[68:71], v[160:163]
    ds_read_b64_tr_b16 v[48:49], v5 offset:40960
    v_mfma_f32_16x16x32_bf16 v[164:167], v[100:103], v[68:71], v[164:167]
    ds_read_b64_tr_b16 v[50:51], v5 offset:41984
    v_mfma_f32_16x16x32_bf16 v[168:171], v[104:107], v[68:71], v[168:171]
    ds_read_b64_tr_b16 v[52:53], v6 offset:40960
    v_mfma_f32_16x16x32_bf16 v[172:175], v[108:111], v[68:71], v[172:175]
    ds_read_b64_tr_b16 v[54:55], v6 offset:41984
    v_mfma_f32_16x16x32_bf16 v[176:179], v[80:83], v[72:75], v[176:179]
    ds_read_b64_tr_b16 v[56:57], v7 offset:40960
    v_mfma_f32_16x16x32_bf16 v[180:183], v[84:87], v[72:75], v[180:183]
    ds_read_b64_tr_b16 v[58:59], v7 offset:41984
    v_mfma_f32_16x16x32_bf16 v[184:187], v[88:91], v[72:75], v[184:187]
    ds_read_b64_tr_b16 v[60:61], v8 offset:40960
    v_mfma_f32_16x16x32_bf16 v[188:191], v[92:95], v[72:75], v[188:191]
    ds_read_b64_tr_b16 v[62:63], v8 offset:41984
    v_mfma_f32_16x16x32_bf16 v[192:195], v[96:99], v[72:75], v[192:195]
    v_mfma_f32_16x16x32_bf16 v[196:199], v[100:103], v[72:75], v[196:199]
    v_mfma_f32_16x16x32_bf16 v[200:203], v[104:107], v[72:75], v[200:203]
    v_mfma_f32_16x16x32_bf16 v[204:207], v[108:111], v[72:75], v[204:207]
    v_mfma_f32_16x16x32_bf16 v[208:211], v[80:83], v[76:79], v[208:211]
    v_mfma_f32_16x16x32_bf16 v[212:215], v[84:87], v[76:79], v[212:215]
    v_mfma_f32_16x16x32_bf16 v[216:219], v[88:91], v[76:79], v[216:219]
    v_mfma_f32_16x16x32_bf16 v[220:223], v[92:95], v[76:79], v[220:223]
    v_mfma_f32_16x16x32_bf16 v[224:227], v[96:99], v[76:79], v[224:227]
    v_mfma_f32_16x16x32_bf16 v[228:231], v[100:103], v[76:79], v[228:231]
    v_mfma_f32_16x16x32_bf16 v[232:235], v[104:107], v[76:79], v[232:235]
    v_mfma_f32_16x16x32_bf16 v[236:239], v[108:111], v[76:79], v[236:239]
    s_waitcnt lgkmcnt(0)
    s_barrier
    v_mfma_f32_16x16x32_bf16 v[112:115], v[32:35], v[16:19], v[112:115]
    ds_read_b128 v[64:67], v4 offset:16384
    v_mfma_f32_16x16x32_bf16 v[116:119], v[36:39], v[16:19], v[116:119]
    ds_read_b128 v[68:71], v4 offset:18432
    v_mfma_f32_16x16x32_bf16 v[120:123], v[40:43], v[16:19], v[120:123]
    ds_read_b128 v[72:75], v4 offset:20480
    v_mfma_f32_16x16x32_bf16 v[124:127], v[44:47], v[16:19], v[124:127]
    ds_read_b128 v[76:79], v4 offset:22528
    v_mfma_f32_16x16x32_bf16 v[128:131], v[48:51], v[16:19], v[128:131]
    ds_read_b64_tr_b16 v[80:81], v5 offset:49152
    v_mfma_f32_16x16x32_bf16 v[132:135], v[52:55], v[16:19], v[132:135]
    ds_read_b64_tr_b16 v[82:83], v5 offset:50176
    v_mfma_f32_16x16x32_bf16 v[136:139], v[56:59], v[16:19], v[136:139]
    ds_read_b64_tr_b16 v[84:85], v6 offset:49152
    v_mfma_f32_16x16x32_bf16 v[140:143], v[60:63], v[16:19], v[140:143]
    ds_read_b64_tr_b16 v[86:87], v6 offset:50176
    v_mfma_f32_16x16x32_bf16 v[144:147], v[32:35], v[20:23], v[144:147]
    ds_read_b64_tr_b16 v[88:89], v7 offset:49152
    v_mfma_f32_16x16x32_bf16 v[148:151], v[36:39], v[20:23], v[148:151]
    ds_read_b64_tr_b16 v[90:91], v7 offset:50176
    v_mfma_f32_16x16x32_bf16 v[152:155], v[40:43], v[20:23], v[152:155]
    ds_read_b64_tr_b16 v[92:93], v8 offset:49152
    v_mfma_f32_16x16x32_bf16 v[156:159], v[44:47], v[20:23], v[156:159]
    ds_read_b64_tr_b16 v[94:95], v8 offset:50176
    v_mfma_f32_16x16x32_bf16 v[160:163], v[48:51], v[20:23], v[160:163]
    ds_read_b64_tr_b16 v[96:97], v5 offset:57344
    v_mfma_f32_16x16x32_bf16 v[164:167], v[52:55], v[20:23], v[164:167]
    ds_read_b64_tr_b16 v[98:99], v5 offset:58368
    v_mfma_f32_16x16x32_bf16 v[168:171], v[56:59], v[20:23], v[168:171]
    ds_read_b64_tr_b16 v[100:101], v6 offset:57344
    v_mfma_f32_16x16x32_bf16 v[172:175], v[60:63], v[20:23], v[172:175]
    ds_read_b64_tr_b16 v[102:103], v6 offset:58368
    v_mfma_f32_16x16x32_bf16 v[176:179], v[32:35], v[24:27], v[176:179]
    ds_read_b64_tr_b16 v[104:105], v7 offset:57344
    v_mfma_f32_16x16x32_bf16 v[180:183], v[36:39], v[24:27], v[180:183]
    ds_read_b64_tr_b16 v[106:107], v7 offset:58368
    v_mfma_f32_16x16x32_bf16 v[184:187], v[40:43], v[24:27], v[184:187]
    ds_read_b64_tr_b16 v[108:109], v8 offset:57344
    v_mfma_f32_16x16x32_bf16 v[188:191], v[44:47], v[24:27], v[188:191]
    ds_read_b64_tr_b16 v[110:111], v8 offset:58368
    v_mfma_f32_16x16x32_bf16 v[192:195], v[48:51], v[24:27], v[192:195]
    v_mfma_f32_16x16x32_bf16 v[196:199], v[52:55], v[24:27], v[196:199]
    v_mfma_f32_16x16x32_bf16 v[200:203], v[56:59], v[24:27], v[200:203]
    v_mfma_f32_16x16x32_bf16 v[204:207], v[60:63], v[24:27], v[204:207]
    v_mfma_f32_16x16x32_bf16 v[208:211], v[32:35], v[28:31], v[208:211]
    v_mfma_f32_16x16x32_bf16 v[212:215], v[36:39], v[28:31], v[212:215]
    v_mfma_f32_16x16x32_bf16 v[216:219], v[40:43], v[28:31], v[216:219]
    v_mfma_f32_16x16x32_bf16 v[220:223], v[44:47], v[28:31], v[220:223]
    v_mfma_f32_16x16x32_bf16 v[224:227], v[48:51], v[28:31], v[224:227]
    v_mfma_f32_16x16x32_bf16 v[228:231], v[52:55], v[28:31], v[228:231]
    v_mfma_f32_16x16x32_bf16 v[232:235], v[56:59], v[28:31], v[232:235]
    v_mfma_f32_16x16x32_bf16 v[236:239], v[60:63], v[28:31], v[236:239]
    s_waitcnt lgkmcnt(0)
    s_barrier
    v_mfma_f32_16x16x32_bf16 v[112:115], v[80:83], v[64:67], v[112:115]
    ds_read_b128 v[16:19], v9 offset:0
    v_mfma_f32_16x16x32_bf16 v[116:119], v[84:87], v[64:67], v[116:119]
    ds_read_b128 v[20:23], v9 offset:256
    v_mfma_f32_16x16x32_bf16 v[120:123], v[88:91], v[64:67], v[120:123]
    ds_read_b128 v[24:27], v9 offset:512
    v_mfma_f32_16x16x32_bf16 v[124:127], v[92:95], v[64:67], v[124:127]
    ds_read_b128 v[28:31], v9 offset:768
    v_mfma_f32_16x16x32_bf16 v[128:131], v[96:99], v[64:67], v[128:131]
    ds_read_b128 v[32:35], v10 offset:0
    v_mfma_f32_16x16x32_bf16 v[132:135], v[100:103], v[64:67], v[132:135]
    ds_read_b128 v[36:39], v10 offset:64
    v_mfma_f32_16x16x32_bf16 v[136:139], v[104:107], v[64:67], v[136:139]
    ds_read_b128 v[40:43], v10 offset:128
    v_mfma_f32_16x16x32_bf16 v[140:143], v[108:111], v[64:67], v[140:143]
    ds_read_b128 v[44:47], v10 offset:192
    v_mfma_f32_16x16x32_bf16 v[144:147], v[80:83], v[68:71], v[144:147]
    ds_read_b128 v[48:51], v10 offset:512
    v_mfma_f32_16x16x32_bf16 v[148:151], v[84:87], v[68:71], v[148:151]
    ds_read_b128 v[52:55], v10 offset:576
    v_mfma_f32_16x16x32_bf16 v[152:155], v[88:91], v[68:71], v[152:155]
    ds_read_b128 v[56:59], v10 offset:640
    v_mfma_f32_16x16x32_bf16 v[156:159], v[92:95], v[68:71], v[156:159]
    ds_read_b128 v[60:63], v10 offset:704
    v_mfma_f32_16x16x32_bf16 v[160:163], v[96:99], v[68:71], v[160:163]
    v_mfma_f32_16x16x32_bf16 v[164:167], v[100:103], v[68:71], v[164:167]
    v_mfma_f32_16x16x32_bf16 v[168:171], v[104:107], v[68:71], v[168:171]
    v_mfma_f32_16x16x32_bf16 v[172:175], v[108:111], v[68:71], v[172:175]
    v_mfma_f32_16x16x32_bf16 v[176:179], v[80:83], v[72:75], v[176:179]
    v_mfma_f32_16x16x32_bf16 v[180:183], v[84:87], v[72:75], v[180:183]
    v_mfma_f32_16x16x32_bf16 v[184:187], v[88:91], v[72:75], v[184:187]
    v_mfma_f32_16x16x32_bf16 v[188:191], v[92:95], v[72:75], v[188:191]
    v_mfma_f32_16x16x32_bf16 v[192:195], v[96:99], v[72:75], v[192:195]
    v_mfma_f32_16x16x32_bf16 v[196:199], v[100:103], v[72:75], v[196:199]
    v_mfma_f32_16x16x32_bf16 v[200:203], v[104:107], v[72:75], v[200:203]
    v_mfma_f32_16x16x32_bf16 v[204:207], v[108:111], v[72:75], v[204:207]
    v_mfma_f32_16x16x32_bf16 v[208:211], v[80:83], v[76:79], v[208:211]
    v_mfma_f32_16x16x32_bf16 v[212:215], v[84:87], v[76:79], v[212:215]
    v_mfma_f32_16x16x32_bf16 v[216:219], v[88:91], v[76:79], v[216:219]
    v_mfma_f32_16x16x32_bf16 v[220:223], v[92:95], v[76:79], v[220:223]
    v_mfma_f32_16x16x32_bf16 v[224:227], v[96:99], v[76:79], v[224:227]
    v_mfma_f32_16x16x32_bf16 v[228:231], v[100:103], v[76:79], v[228:231]
    v_mfma_f32_16x16x32_bf16 v[232:235], v[104:107], v[76:79], v[232:235]
    v_mfma_f32_16x16x32_bf16 v[236:239], v[108:111], v[76:79], v[236:239]
    s_waitcnt lgkmcnt(0)
    v_fma_f32 v112, -v16, v32, v112
    v_fma_f32 v113, -v16, v33, v113
    v_fma_f32 v114, -v16, v34, v114
    v_fma_f32 v115, -v16, v35, v115
    v_mul_f32 v64, v17, v112
    v_mul_f32 v65, v17, v113
    v_mul_f32 v66, v17, v114
    v_mul_f32 v67, v17, v115
    v_exp_f32 v64, v64
    v_exp_f32 v65, v65
    v_exp_f32 v66, v66
    v_exp_f32 v67, v67
    v_fma_f32 v128, -v16, v48, v128
    v_fma_f32 v129, -v16, v49, v129
    v_fma_f32 v130, -v16, v50, v130
    v_fma_f32 v131, -v16, v51, v131
    v_fma_f32 v64, v64, v18, v18
    v_fma_f32 v65, v65, v18, v18
    v_fma_f32 v66, v66, v18, v18
    v_fma_f32 v67, v67, v18, v18
    v_rcp_f32 v64, v64
    v_rcp_f32 v65, v65
    v_rcp_f32 v66, v66
    v_rcp_f32 v67, v67
    v_mul_f32 v112, v112, v128
    v_mul_f32 v113, v113, v129
    v_mul_f32 v114, v114, v130
    v_mul_f32 v115, v115, v131
    v_mul_f32 v112, v112, v64
    v_mul_f32 v113, v113, v65
    v_mul_f32 v114, v114, v66
    v_mul_f32 v115, v115, v67
    v_cvt_pk_bf16_f32 v80, v112, v113
    v_cvt_pk_bf16_f32 v81, v114, v115
    v_fma_f32 v116, -v16, v36, v116
    v_fma_f32 v117, -v16, v37, v117
    v_fma_f32 v118, -v16, v38, v118
    v_fma_f32 v119, -v16, v39, v119
    v_mul_f32 v68, v17, v116
    v_mul_f32 v69, v17, v117
    v_mul_f32 v70, v17, v118
    v_mul_f32 v71, v17, v119
    v_exp_f32 v68, v68
    v_exp_f32 v69, v69
    v_exp_f32 v70, v70
    v_exp_f32 v71, v71
    v_fma_f32 v132, -v16, v52, v132
    v_fma_f32 v133, -v16, v53, v133
    v_fma_f32 v134, -v16, v54, v134
    v_fma_f32 v135, -v16, v55, v135
    v_fma_f32 v68, v68, v18, v18
    v_fma_f32 v69, v69, v18, v18
    v_fma_f32 v70, v70, v18, v18
    v_fma_f32 v71, v71, v18, v18
    v_rcp_f32 v68, v68
    v_rcp_f32 v69, v69
    v_rcp_f32 v70, v70
    v_rcp_f32 v71, v71
    v_mul_f32 v116, v116, v132
    v_mul_f32 v117, v117, v133
    v_mul_f32 v118, v118, v134
    v_mul_f32 v119, v119, v135
    v_mul_f32 v116, v116, v68
    v_mul_f32 v117, v117, v69
    v_mul_f32 v118, v118, v70
    v_mul_f32 v119, v119, v71
    v_cvt_pk_bf16_f32 v82, v116, v117
    v_cvt_pk_bf16_f32 v83, v118, v119
    buffer_store_dwordx4 v[80:83], v11, s[28:31], s78 offen offset:0 sc1
    v_fma_f32 v120, -v16, v40, v120
    v_fma_f32 v121, -v16, v41, v121
    v_fma_f32 v122, -v16, v42, v122
    v_fma_f32 v123, -v16, v43, v123
    v_mul_f32 v64, v17, v120
    v_mul_f32 v65, v17, v121
    v_mul_f32 v66, v17, v122
    v_mul_f32 v67, v17, v123
    v_exp_f32 v64, v64
    v_exp_f32 v65, v65
    v_exp_f32 v66, v66
    v_exp_f32 v67, v67
    v_fma_f32 v136, -v16, v56, v136
    v_fma_f32 v137, -v16, v57, v137
    v_fma_f32 v138, -v16, v58, v138
    v_fma_f32 v139, -v16, v59, v139
    v_fma_f32 v64, v64, v18, v18
    v_fma_f32 v65, v65, v18, v18
    v_fma_f32 v66, v66, v18, v18
    v_fma_f32 v67, v67, v18, v18
    v_rcp_f32 v64, v64
    v_rcp_f32 v65, v65
    v_rcp_f32 v66, v66
    v_rcp_f32 v67, v67
    v_mul_f32 v120, v120, v136
    v_mul_f32 v121, v121, v137
    v_mul_f32 v122, v122, v138
    v_mul_f32 v123, v123, v139
    v_mul_f32 v120, v120, v64
    v_mul_f32 v121, v121, v65
    v_mul_f32 v122, v122, v66
    v_mul_f32 v123, v123, v67
    v_cvt_pk_bf16_f32 v84, v120, v121
    v_cvt_pk_bf16_f32 v85, v122, v123
    v_fma_f32 v124, -v16, v44, v124
    v_fma_f32 v125, -v16, v45, v125
    v_fma_f32 v126, -v16, v46, v126
    v_fma_f32 v127, -v16, v47, v127
    v_mul_f32 v68, v17, v124
    v_mul_f32 v69, v17, v125
    v_mul_f32 v70, v17, v126
    v_mul_f32 v71, v17, v127
    v_exp_f32 v68, v68
    v_exp_f32 v69, v69
    v_exp_f32 v70, v70
    v_exp_f32 v71, v71
    v_fma_f32 v140, -v16, v60, v140
    v_fma_f32 v141, -v16, v61, v141
    v_fma_f32 v142, -v16, v62, v142
    v_fma_f32 v143, -v16, v63, v143
    v_fma_f32 v68, v68, v18, v18
    v_fma_f32 v69, v69, v18, v18
    v_fma_f32 v70, v70, v18, v18
    v_fma_f32 v71, v71, v18, v18
    v_rcp_f32 v68, v68
    v_rcp_f32 v69, v69
    v_rcp_f32 v70, v70
    v_rcp_f32 v71, v71
    v_mul_f32 v124, v124, v140
    v_mul_f32 v125, v125, v141
    v_mul_f32 v126, v126, v142
    v_mul_f32 v127, v127, v143
    v_mul_f32 v124, v124, v68
    v_mul_f32 v125, v125, v69
    v_mul_f32 v126, v126, v70
    v_mul_f32 v127, v127, v71
    v_cvt_pk_bf16_f32 v86, v124, v125
    v_cvt_pk_bf16_f32 v87, v126, v127
    buffer_store_dwordx4 v[84:87], v11, s[28:31], s78 offen offset:1024 sc1
    s_add_u32 s78, s78, 57344
    v_fma_f32 v144, -v20, v32, v144
    v_fma_f32 v145, -v20, v33, v145
    v_fma_f32 v146, -v20, v34, v146
    v_fma_f32 v147, -v20, v35, v147
    v_mul_f32 v64, v21, v144
    v_mul_f32 v65, v21, v145
    v_mul_f32 v66, v21, v146
    v_mul_f32 v67, v21, v147
    v_exp_f32 v64, v64
    v_exp_f32 v65, v65
    v_exp_f32 v66, v66
    v_exp_f32 v67, v67
    v_fma_f32 v160, -v20, v48, v160
    v_fma_f32 v161, -v20, v49, v161
    v_fma_f32 v162, -v20, v50, v162
    v_fma_f32 v163, -v20, v51, v163
    v_fma_f32 v64, v64, v22, v22
    v_fma_f32 v65, v65, v22, v22
    v_fma_f32 v66, v66, v22, v22
    v_fma_f32 v67, v67, v22, v22
    v_rcp_f32 v64, v64
    v_rcp_f32 v65, v65
    v_rcp_f32 v66, v66
    v_rcp_f32 v67, v67
    v_mul_f32 v144, v144, v160
    v_mul_f32 v145, v145, v161
    v_mul_f32 v146, v146, v162
    v_mul_f32 v147, v147, v163
    v_mul_f32 v144, v144, v64
    v_mul_f32 v145, v145, v65
    v_mul_f32 v146, v146, v66
    v_mul_f32 v147, v147, v67
    v_cvt_pk_bf16_f32 v80, v144, v145
    v_cvt_pk_bf16_f32 v81, v146, v147
    v_fma_f32 v148, -v20, v36, v148
    v_fma_f32 v149, -v20, v37, v149
    v_fma_f32 v150, -v20, v38, v150
    v_fma_f32 v151, -v20, v39, v151
    v_mul_f32 v68, v21, v148
    v_mul_f32 v69, v21, v149
    v_mul_f32 v70, v21, v150
    v_mul_f32 v71, v21, v151
    v_exp_f32 v68, v68
    v_exp_f32 v69, v69
    v_exp_f32 v70, v70
    v_exp_f32 v71, v71
    v_fma_f32 v164, -v20, v52, v164
    v_fma_f32 v165, -v20, v53, v165
    v_fma_f32 v166, -v20, v54, v166
    v_fma_f32 v167, -v20, v55, v167
    v_fma_f32 v68, v68, v22, v22
    v_fma_f32 v69, v69, v22, v22
    v_fma_f32 v70, v70, v22, v22
    v_fma_f32 v71, v71, v22, v22
    v_rcp_f32 v68, v68
    v_rcp_f32 v69, v69
    v_rcp_f32 v70, v70
    v_rcp_f32 v71, v71
    v_mul_f32 v148, v148, v164
    v_mul_f32 v149, v149, v165
    v_mul_f32 v150, v150, v166
    v_mul_f32 v151, v151, v167
    v_mul_f32 v148, v148, v68
    v_mul_f32 v149, v149, v69
    v_mul_f32 v150, v150, v70
    v_mul_f32 v151, v151, v71
    v_cvt_pk_bf16_f32 v82, v148, v149
    v_cvt_pk_bf16_f32 v83, v150, v151
    buffer_store_dwordx4 v[80:83], v11, s[28:31], s78 offen offset:0 sc1
    v_fma_f32 v152, -v20, v40, v152
    v_fma_f32 v153, -v20, v41, v153
    v_fma_f32 v154, -v20, v42, v154
    v_fma_f32 v155, -v20, v43, v155
    v_mul_f32 v64, v21, v152
    v_mul_f32 v65, v21, v153
    v_mul_f32 v66, v21, v154
    v_mul_f32 v67, v21, v155
    v_exp_f32 v64, v64
    v_exp_f32 v65, v65
    v_exp_f32 v66, v66
    v_exp_f32 v67, v67
    v_fma_f32 v168, -v20, v56, v168
    v_fma_f32 v169, -v20, v57, v169
    v_fma_f32 v170, -v20, v58, v170
    v_fma_f32 v171, -v20, v59, v171
    v_fma_f32 v64, v64, v22, v22
    v_fma_f32 v65, v65, v22, v22
    v_fma_f32 v66, v66, v22, v22
    v_fma_f32 v67, v67, v22, v22
    v_rcp_f32 v64, v64
    v_rcp_f32 v65, v65
    v_rcp_f32 v66, v66
    v_rcp_f32 v67, v67
    v_mul_f32 v152, v152, v168
    v_mul_f32 v153, v153, v169
    v_mul_f32 v154, v154, v170
    v_mul_f32 v155, v155, v171
    v_mul_f32 v152, v152, v64
    v_mul_f32 v153, v153, v65
    v_mul_f32 v154, v154, v66
    v_mul_f32 v155, v155, v67
    v_cvt_pk_bf16_f32 v84, v152, v153
    v_cvt_pk_bf16_f32 v85, v154, v155
    v_fma_f32 v156, -v20, v44, v156
    v_fma_f32 v157, -v20, v45, v157
    v_fma_f32 v158, -v20, v46, v158
    v_fma_f32 v159, -v20, v47, v159
    v_mul_f32 v68, v21, v156
    v_mul_f32 v69, v21, v157
    v_mul_f32 v70, v21, v158
    v_mul_f32 v71, v21, v159
    v_exp_f32 v68, v68
    v_exp_f32 v69, v69
    v_exp_f32 v70, v70
    v_exp_f32 v71, v71
    v_fma_f32 v172, -v20, v60, v172
    v_fma_f32 v173, -v20, v61, v173
    v_fma_f32 v174, -v20, v62, v174
    v_fma_f32 v175, -v20, v63, v175
    v_fma_f32 v68, v68, v22, v22
    v_fma_f32 v69, v69, v22, v22
    v_fma_f32 v70, v70, v22, v22
    v_fma_f32 v71, v71, v22, v22
    v_rcp_f32 v68, v68
    v_rcp_f32 v69, v69
    v_rcp_f32 v70, v70
    v_rcp_f32 v71, v71
    v_mul_f32 v156, v156, v172
    v_mul_f32 v157, v157, v173
    v_mul_f32 v158, v158, v174
    v_mul_f32 v159, v159, v175
    v_mul_f32 v156, v156, v68
    v_mul_f32 v157, v157, v69
    v_mul_f32 v158, v158, v70
    v_mul_f32 v159, v159, v71
    v_cvt_pk_bf16_f32 v86, v156, v157
    v_cvt_pk_bf16_f32 v87, v158, v159
    buffer_store_dwordx4 v[84:87], v11, s[28:31], s78 offen offset:1024 sc1
    s_add_u32 s78, s78, 57344
    v_fma_f32 v176, -v24, v32, v176
    v_fma_f32 v177, -v24, v33, v177
    v_fma_f32 v178, -v24, v34, v178
    v_fma_f32 v179, -v24, v35, v179
    v_mul_f32 v64, v25, v176
    v_mul_f32 v65, v25, v177
    v_mul_f32 v66, v25, v178
    v_mul_f32 v67, v25, v179
    v_exp_f32 v64, v64
    v_exp_f32 v65, v65
    v_exp_f32 v66, v66
    v_exp_f32 v67, v67
    v_fma_f32 v192, -v24, v48, v192
    v_fma_f32 v193, -v24, v49, v193
    v_fma_f32 v194, -v24, v50, v194
    v_fma_f32 v195, -v24, v51, v195
    v_fma_f32 v64, v64, v26, v26
    v_fma_f32 v65, v65, v26, v26
    v_fma_f32 v66, v66, v26, v26
    v_fma_f32 v67, v67, v26, v26
    v_rcp_f32 v64, v64
    v_rcp_f32 v65, v65
    v_rcp_f32 v66, v66
    v_rcp_f32 v67, v67
    v_mul_f32 v176, v176, v192
    v_mul_f32 v177, v177, v193
    v_mul_f32 v178, v178, v194
    v_mul_f32 v179, v179, v195
    v_mul_f32 v176, v176, v64
    v_mul_f32 v177, v177, v65
    v_mul_f32 v178, v178, v66
    v_mul_f32 v179, v179, v67
    v_cvt_pk_bf16_f32 v80, v176, v177
    v_cvt_pk_bf16_f32 v81, v178, v179
    v_fma_f32 v180, -v24, v36, v180
    v_fma_f32 v181, -v24, v37, v181
    v_fma_f32 v182, -v24, v38, v182
    v_fma_f32 v183, -v24, v39, v183
    v_mul_f32 v68, v25, v180
    v_mul_f32 v69, v25, v181
    v_mul_f32 v70, v25, v182
    v_mul_f32 v71, v25, v183
    v_exp_f32 v68, v68
    v_exp_f32 v69, v69
    v_exp_f32 v70, v70
    v_exp_f32 v71, v71
    v_fma_f32 v196, -v24, v52, v196
    v_fma_f32 v197, -v24, v53, v197
    v_fma_f32 v198, -v24, v54, v198
    v_fma_f32 v199, -v24, v55, v199
    v_fma_f32 v68, v68, v26, v26
    v_fma_f32 v69, v69, v26, v26
    v_fma_f32 v70, v70, v26, v26
    v_fma_f32 v71, v71, v26, v26
    v_rcp_f32 v68, v68
    v_rcp_f32 v69, v69
    v_rcp_f32 v70, v70
    v_rcp_f32 v71, v71
    v_mul_f32 v180, v180, v196
    v_mul_f32 v181, v181, v197
    v_mul_f32 v182, v182, v198
    v_mul_f32 v183, v183, v199
    v_mul_f32 v180, v180, v68
    v_mul_f32 v181, v181, v69
    v_mul_f32 v182, v182, v70
    v_mul_f32 v183, v183, v71
    v_cvt_pk_bf16_f32 v82, v180, v181
    v_cvt_pk_bf16_f32 v83, v182, v183
    buffer_store_dwordx4 v[80:83], v11, s[28:31], s78 offen offset:0 sc1
    v_fma_f32 v184, -v24, v40, v184
    v_fma_f32 v185, -v24, v41, v185
    v_fma_f32 v186, -v24, v42, v186
    v_fma_f32 v187, -v24, v43, v187
    v_mul_f32 v64, v25, v184
    v_mul_f32 v65, v25, v185
    v_mul_f32 v66, v25, v186
    v_mul_f32 v67, v25, v187
    v_exp_f32 v64, v64
    v_exp_f32 v65, v65
    v_exp_f32 v66, v66
    v_exp_f32 v67, v67
    v_fma_f32 v200, -v24, v56, v200
    v_fma_f32 v201, -v24, v57, v201
    v_fma_f32 v202, -v24, v58, v202
    v_fma_f32 v203, -v24, v59, v203
    v_fma_f32 v64, v64, v26, v26
    v_fma_f32 v65, v65, v26, v26
    v_fma_f32 v66, v66, v26, v26
    v_fma_f32 v67, v67, v26, v26
    v_rcp_f32 v64, v64
    v_rcp_f32 v65, v65
    v_rcp_f32 v66, v66
    v_rcp_f32 v67, v67
    v_mul_f32 v184, v184, v200
    v_mul_f32 v185, v185, v201
    v_mul_f32 v186, v186, v202
    v_mul_f32 v187, v187, v203
    v_mul_f32 v184, v184, v64
    v_mul_f32 v185, v185, v65
    v_mul_f32 v186, v186, v66
    v_mul_f32 v187, v187, v67
    v_cvt_pk_bf16_f32 v84, v184, v185
    v_cvt_pk_bf16_f32 v85, v186, v187
    v_fma_f32 v188, -v24, v44, v188
    v_fma_f32 v189, -v24, v45, v189
    v_fma_f32 v190, -v24, v46, v190
    v_fma_f32 v191, -v24, v47, v191
    v_mul_f32 v68, v25, v188
    v_mul_f32 v69, v25, v189
    v_mul_f32 v70, v25, v190
    v_mul_f32 v71, v25, v191
    v_exp_f32 v68, v68
    v_exp_f32 v69, v69
    v_exp_f32 v70, v70
    v_exp_f32 v71, v71
    v_fma_f32 v204, -v24, v60, v204
    v_fma_f32 v205, -v24, v61, v205
    v_fma_f32 v206, -v24, v62, v206
    v_fma_f32 v207, -v24, v63, v207
    v_fma_f32 v68, v68, v26, v26
    v_fma_f32 v69, v69, v26, v26
    v_fma_f32 v70, v70, v26, v26
    v_fma_f32 v71, v71, v26, v26
    v_rcp_f32 v68, v68
    v_rcp_f32 v69, v69
    v_rcp_f32 v70, v70
    v_rcp_f32 v71, v71
    v_mul_f32 v188, v188, v204
    v_mul_f32 v189, v189, v205
    v_mul_f32 v190, v190, v206
    v_mul_f32 v191, v191, v207
    v_mul_f32 v188, v188, v68
    v_mul_f32 v189, v189, v69
    v_mul_f32 v190, v190, v70
    v_mul_f32 v191, v191, v71
    v_cvt_pk_bf16_f32 v86, v188, v189
    v_cvt_pk_bf16_f32 v87, v190, v191
    buffer_store_dwordx4 v[84:87], v11, s[28:31], s78 offen offset:1024 sc1
    s_add_u32 s78, s78, 57344
    v_fma_f32 v208, -v28, v32, v208
    v_fma_f32 v209, -v28, v33, v209
    v_fma_f32 v210, -v28, v34, v210
    v_fma_f32 v211, -v28, v35, v211
    v_mul_f32 v64, v29, v208
    v_mul_f32 v65, v29, v209
    v_mul_f32 v66, v29, v210
    v_mul_f32 v67, v29, v211
    v_exp_f32 v64, v64
    v_exp_f32 v65, v65
    v_exp_f32 v66, v66
    v_exp_f32 v67, v67
    v_fma_f32 v224, -v28, v48, v224
    v_fma_f32 v225, -v28, v49, v225
    v_fma_f32 v226, -v28, v50, v226
    v_fma_f32 v227, -v28, v51, v227
    v_fma_f32 v64, v64, v30, v30
    v_fma_f32 v65, v65, v30, v30
    v_fma_f32 v66, v66, v30, v30
    v_fma_f32 v67, v67, v30, v30
    v_rcp_f32 v64, v64
    v_rcp_f32 v65, v65
    v_rcp_f32 v66, v66
    v_rcp_f32 v67, v67
    v_mul_f32 v208, v208, v224
    v_mul_f32 v209, v209, v225
    v_mul_f32 v210, v210, v226
    v_mul_f32 v211, v211, v227
    v_mul_f32 v208, v208, v64
    v_mul_f32 v209, v209, v65
    v_mul_f32 v210, v210, v66
    v_mul_f32 v211, v211, v67
    v_cvt_pk_bf16_f32 v80, v208, v209
    v_cvt_pk_bf16_f32 v81, v210, v211
    v_fma_f32 v212, -v28, v36, v212
    v_fma_f32 v213, -v28, v37, v213
    v_fma_f32 v214, -v28, v38, v214
    v_fma_f32 v215, -v28, v39, v215
    v_mul_f32 v68, v29, v212
    v_mul_f32 v69, v29, v213
    v_mul_f32 v70, v29, v214
    v_mul_f32 v71, v29, v215
    v_exp_f32 v68, v68
    v_exp_f32 v69, v69
    v_exp_f32 v70, v70
    v_exp_f32 v71, v71
    v_fma_f32 v228, -v28, v52, v228
    v_fma_f32 v229, -v28, v53, v229
    v_fma_f32 v230, -v28, v54, v230
    v_fma_f32 v231, -v28, v55, v231
    v_fma_f32 v68, v68, v30, v30
    v_fma_f32 v69, v69, v30, v30
    v_fma_f32 v70, v70, v30, v30
    v_fma_f32 v71, v71, v30, v30
    v_rcp_f32 v68, v68
    v_rcp_f32 v69, v69
    v_rcp_f32 v70, v70
    v_rcp_f32 v71, v71
    v_mul_f32 v212, v212, v228
    v_mul_f32 v213, v213, v229
    v_mul_f32 v214, v214, v230
    v_mul_f32 v215, v215, v231
    v_mul_f32 v212, v212, v68
    v_mul_f32 v213, v213, v69
    v_mul_f32 v214, v214, v70
    v_mul_f32 v215, v215, v71
    v_cvt_pk_bf16_f32 v82, v212, v213
    v_cvt_pk_bf16_f32 v83, v214, v215
    buffer_store_dwordx4 v[80:83], v11, s[28:31], s78 offen offset:0 sc1
    v_fma_f32 v216, -v28, v40, v216
    v_fma_f32 v217, -v28, v41, v217
    v_fma_f32 v218, -v28, v42, v218
    v_fma_f32 v219, -v28, v43, v219
    v_mul_f32 v64, v29, v216
    v_mul_f32 v65, v29, v217
    v_mul_f32 v66, v29, v218
    v_mul_f32 v67, v29, v219
    v_exp_f32 v64, v64
    v_exp_f32 v65, v65
    v_exp_f32 v66, v66
    v_exp_f32 v67, v67
    v_fma_f32 v232, -v28, v56, v232
    v_fma_f32 v233, -v28, v57, v233
    v_fma_f32 v234, -v28, v58, v234
    v_fma_f32 v235, -v28, v59, v235
    v_fma_f32 v64, v64, v30, v30
    v_fma_f32 v65, v65, v30, v30
    v_fma_f32 v66, v66, v30, v30
    v_fma_f32 v67, v67, v30, v30
    v_rcp_f32 v64, v64
    v_rcp_f32 v65, v65
    v_rcp_f32 v66, v66
    v_rcp_f32 v67, v67
    v_mul_f32 v216, v216, v232
    v_mul_f32 v217, v217, v233
    v_mul_f32 v218, v218, v234
    v_mul_f32 v219, v219, v235
    v_mul_f32 v216, v216, v64
    v_mul_f32 v217, v217, v65
    v_mul_f32 v218, v218, v66
    v_mul_f32 v219, v219, v67
    v_cvt_pk_bf16_f32 v84, v216, v217
    v_cvt_pk_bf16_f32 v85, v218, v219
    v_fma_f32 v220, -v28, v44, v220
    v_fma_f32 v221, -v28, v45, v221
    v_fma_f32 v222, -v28, v46, v222
    v_fma_f32 v223, -v28, v47, v223
    v_mul_f32 v68, v29, v220
    v_mul_f32 v69, v29, v221
    v_mul_f32 v70, v29, v222
    v_mul_f32 v71, v29, v223
    v_exp_f32 v68, v68
    v_exp_f32 v69, v69
    v_exp_f32 v70, v70
    v_exp_f32 v71, v71
    v_fma_f32 v236, -v28, v60, v236
    v_fma_f32 v237, -v28, v61, v237
    v_fma_f32 v238, -v28, v62, v238
    v_fma_f32 v239, -v28, v63, v239
    v_fma_f32 v68, v68, v30, v30
    v_fma_f32 v69, v69, v30, v30
    v_fma_f32 v70, v70, v30, v30
    v_fma_f32 v71, v71, v30, v30
    v_rcp_f32 v68, v68
    v_rcp_f32 v69, v69
    v_rcp_f32 v70, v70
    v_rcp_f32 v71, v71
    v_mul_f32 v220, v220, v236
    v_mul_f32 v221, v221, v237
    v_mul_f32 v222, v222, v238
    v_mul_f32 v223, v223, v239
    v_mul_f32 v220, v220, v68
    v_mul_f32 v221, v221, v69
    v_mul_f32 v222, v222, v70
    v_mul_f32 v223, v223, v71
    v_cvt_pk_bf16_f32 v86, v220, v221
    v_cvt_pk_bf16_f32 v87, v222, v223
    buffer_store_dwordx4 v[84:87], v11, s[28:31], s78 offen offset:1024 sc1
    s_branch L_J
L_AUX:
    s_and_b32 s56, s2, 3
    s_lshl_b32 s33, s56, 3
    s_and_b32 s56, s2, 4
    s_add_u32 s33, s33, s56
    s_add_u32 s33, s33, s54
    v_lshlrev_b32 v13, 4, v1
    s_lshl_b32 s34, s33, 16
    s_lshl_b32 s35, s32, 13
    s_add_u32 s34, s34, s35
    s_add_u32 s55, s34, 4096
    buffer_load_dwordx4 v[112:115], v13, s[4:7], s34 offen offset:0
    buffer_load_dwordx4 v[116:119], v13, s[4:7], s34 offen offset:1024
    buffer_load_dwordx4 v[120:123], v13, s[4:7], s34 offen offset:2048
    buffer_load_dwordx4 v[124:127], v13, s[4:7], s34 offen offset:3072
    buffer_load_dwordx4 v[128:131], v13, s[4:7], s55 offen offset:0
    buffer_load_dwordx4 v[132:135], v13, s[4:7], s55 offen offset:1024
    buffer_load_dwordx4 v[136:139], v13, s[4:7], s55 offen offset:2048
    buffer_load_dwordx4 v[140:143], v13, s[4:7], s55 offen offset:3072
    s_and_b32 s53, s32, 3
    s_mov_b32 s54, 114688
    s_cmp_eq_u32 s53, 1
    s_cmov_b32 s54, 130192
    s_cmp_eq_u32 s53, 2
    s_cmov_b32 s54, 32768
    s_cmp_eq_u32 s53, 3
    s_cmov_b32 s54, 145696
    v_add_u32 v12, s54, v2
    s_and_b32 s54, s53, 1
    s_lshl_b32 s54, s54, 4
    s_sub_u32 s84, 16, s54
    s_lshr_b32 s54, s53, 1
    s_lshl_b32 s54, s54, 4
    s_sub_u32 s85, 16, s54
    s_waitcnt vmcnt(8) lgkmcnt(0)
    s_cmp_ge_u32 s32, 4
    s_cbranch_scc1 L_AXB
    s_lshl_b32 s55, s59, s85
    s_and_b32 s55, s55, 0xffff0000
    v_lshlrev_b32 v16, s84, v240
    v_lshlrev_b32 v17, s84, v241
    v_lshlrev_b32 v18, s84, v242
    v_lshlrev_b32 v19, s84, v243
    v_and_b32 v16, 0xffff0000, v16
    v_and_b32 v17, 0xffff0000, v17
    v_and_b32 v18, 0xffff0000, v18
    v_and_b32 v19, 0xffff0000, v19
    v_mov_b32 v20, 0x3fb8aa3b
    v_mul_f32 v20, s55, v20
    v_mul_f32 v21, 0x3fb8aa3b, v16
    v_exp_f32 v20, v20
    v_exp_f32 v21, v21
    s_nop 0
    v_cvt_pk_bf16_f32 v20, v20, v20
    v_lshlrev_b32 v20, 16, v20
    v_cvt_pk_bf16_f32 v21, v21, v21
    v_lshlrev_b32 v21, 16, v21
    v_mul_f32 v21, v21, v20
    v_mul_f32 v22, v17, v20
    v_mul_f32 v21, 0xbfb8aa3b, v21
    v_mul_f32 v22, 0x3e22f983, v22
    v_add_f32 v20, v20, v20
    v_mul_f32 v24, v18, v20
    v_mul_f32 v25, -v19, v20
    v_mul_f32 v32, 0x41000000, v21
    v_mul_f32 v33, 0x41000000, v22
    v_mul_f32 v34, 1.0, v21
    v_mul_f32 v35, 1.0, v22
    v_mul_f32 v36, 0x43000000, v21
    v_mul_f32 v37, 0x43000000, v22
    v_mul_f32 v38, 0x42800000, v21
    v_mul_f32 v39, 0x42800000, v22
    v_exp_f32 v32, v32
    v_fract_f32 v33, v33
    v_exp_f32 v34, v34
    v_fract_f32 v35, v35
    v_exp_f32 v36, v36
    v_fract_f32 v37, v37
    v_exp_f32 v38, v38
    v_fract_f32 v39, v39
    v_cos_f32 v40, v33
    v_sin_f32 v41, v33
    v_cos_f32 v42, v35
    v_sin_f32 v43, v35
    v_cos_f32 v44, v37
    v_sin_f32 v45, v37
    v_cos_f32 v46, v39
    v_sin_f32 v47, v39
    s_nop 0
    v_mul_f32 v40, v40, v32
    v_mul_f32 v41, -v41, v32
    v_mul_f32 v42, v42, v34
    v_mul_f32 v43, v43, v34
    v_mul_f32 v44, v44, v36
    v_mul_f32 v45, v45, v36
    v_mul_f32 v46, v46, v38
    v_mul_f32 v47, -v47, v38
    v_mov_b32 v16, 0x00003f80
    ds_write_b32 v12, v16 offset:4352
    v_pk_mul_f32 v[28:29], v[24:25], v[46:47] op_sel:[0,0] op_sel_hi:[0,1]
    v_cvt_pk_bf16_f32 v66, v24, v25
    v_cvt_pk_bf16_f32 v68, v42, v43
    v_pk_fma_f32 v[28:29], v[24:25], v[46:47], v[28:29] op_sel:[1,1,0] op_sel_hi:[1,0,1] neg_lo:[0,1,0]
    ds_write_b32 v12, v66 offset:0
    ds_write_b32 v12, v68 offset:4624
    v_cvt_pk_bf16_f32 v64, v28, v29
    v_pk_mul_f32 v[26:27], v[24:25], v[40:41] op_sel:[0,0] op_sel_hi:[0,1]
    v_cvt_pk_bf16_f32 v69, v44, v45
    ds_write_b32 v12, v64 offset:2176
    v_pk_fma_f32 v[26:27], v[24:25], v[40:41], v[26:27] op_sel:[1,1,0] op_sel_hi:[1,0,1] neg_lo:[0,1,0]
    ds_write_b32 v12, v69 offset:6528
    v_pk_mul_f32 v[30:31], v[28:29], v[40:41] op_sel:[0,0] op_sel_hi:[0,1]
    v_cvt_pk_bf16_f32 v67, v26, v27
    v_pk_mul_f32 v[48:49], v[42:43], v[42:43] op_sel:[0,0] op_sel_hi:[0,1]
    v_pk_fma_f32 v[30:31], v[28:29], v[40:41], v[30:31] op_sel:[1,1,0] op_sel_hi:[1,0,1] neg_lo:[0,1,0]
    ds_write_b32 v12, v67 offset:272
    v_pk_fma_f32 v[48:49], v[42:43], v[42:43], v[48:49] op_sel:[1,1,0] op_sel_hi:[1,0,1] neg_lo:[0,1,0]
    v_cvt_pk_bf16_f32 v65, v30, v31
    v_pk_mul_f32 v[24:25], v[26:27], v[40:41] op_sel:[0,0] op_sel_hi:[0,1]
    v_cvt_pk_bf16_f32 v68, v48, v49
    ds_write_b32 v12, v65 offset:2448
    v_pk_fma_f32 v[24:25], v[26:27], v[40:41], v[24:25] op_sel:[1,1,0] op_sel_hi:[1,0,1] neg_lo:[0,1,0]
    ds_write_b32 v12, v68 offset:4896
    v_pk_mul_f32 v[28:29], v[30:31], v[40:41] op_sel:[0,0] op_sel_hi:[0,1]
    v_cvt_pk_bf16_f32 v66, v24, v25
    v_pk_mul_f32 v[50:51], v[48:49], v[42:43] op_sel:[0,0] op_sel_hi:[0,1]
    v_pk_fma_f32 v[28:29], v[30:31], v[40:41], v[28:29] op_sel:[1,1,0] op_sel_hi:[1,0,1] neg_lo:[0,1,0]
    ds_write_b32 v12, v66 offset:544
    v_pk_fma_f32 v[50:51], v[48:49], v[42:43], v[50:51] op_sel:[1,1,0] op_sel_hi:[1,0,1] neg_lo:[0,1,0]
    v_cvt_pk_bf16_f32 v64, v28, v29
    v_pk_mul_f32 v[26:27], v[24:25], v[40:41] op_sel:[0,0] op_sel_hi:[0,1]
    v_cvt_pk_bf16_f32 v69, v50, v51
    ds_write_b32 v12, v64 offset:2720
    v_pk_fma_f32 v[26:27], v[24:25], v[40:41], v[26:27] op_sel:[1,1,0] op_sel_hi:[1,0,1] neg_lo:[0,1,0]
    ds_write_b32 v12, v69 offset:5168
    v_pk_mul_f32 v[30:31], v[28:29], v[40:41] op_sel:[0,0] op_sel_hi:[0,1]
    v_cvt_pk_bf16_f32 v67, v26, v27
    v_pk_mul_f32 v[52:53], v[50:51], v[42:43] op_sel:[0,0] op_sel_hi:[0,1]
    v_pk_fma_f32 v[30:31], v[28:29], v[40:41], v[30:31] op_sel:[1,1,0] op_sel_hi:[1,0,1] neg_lo:[0,1,0]
    ds_write_b32 v12, v67 offset:816
    v_pk_fma_f32 v[52:53], v[50:51], v[42:43], v[52:53] op_sel:[1,1,0] op_sel_hi:[1,0,1] neg_lo:[0,1,0]
    v_cvt_pk_bf16_f32 v65, v30, v31
    v_pk_mul_f32 v[24:25], v[26:27], v[40:41] op_sel:[0,0] op_sel_hi:[0,1]
    v_cvt_pk_bf16_f32 v68, v52, v53
    ds_write_b32 v12, v65 offset:2992
    v_pk_fma_f32 v[24:25], v[26:27], v[40:41], v[24:25] op_sel:[1,1,0] op_sel_hi:[1,0,1] neg_lo:[0,1,0]
    ds_write_b32 v12, v68 offset:5440
    v_pk_mul_f32 v[28:29], v[30:31], v[40:41] op_sel:[0,0] op_sel_hi:[0,1]
    v_cvt_pk_bf16_f32 v66, v24, v25
    v_pk_mul_f32 v[54:55], v[52:53], v[42:43] op_sel:[0,0] op_sel_hi:[0,1]
    v_pk_fma_f32 v[28:29], v[30:31], v[40:41], v[28:29] op_sel:[1,1,0] op_sel_hi:[1,0,1] neg_lo:[0,1,0]
    ds_write_b32 v12, v66 offset:1088
    v_pk_fma_f32 v[54:55], v[52:53], v[42:43], v[54:55] op_sel:[1,1,0] op_sel_hi:[1,0,1] neg_lo:[0,1,0]
    v_cvt_pk_bf16_f32 v64, v28, v29
    v_pk_mul_f32 v[26:27], v[24:25], v[40:41] op_sel:[0,0] op_sel_hi:[0,1]
    v_cvt_pk_bf16_f32 v69, v54, v55
    ds_write_b32 v12, v64 offset:3264
    v_pk_fma_f32 v[26:27], v[24:25], v[40:41], v[26:27] op_sel:[1,1,0] op_sel_hi:[1,0,1] neg_lo:[0,1,0]
    ds_write_b32 v12, v69 offset:5712
    v_pk_mul_f32 v[30:31], v[28:29], v[40:41] op_sel:[0,0] op_sel_hi:[0,1]
    v_cvt_pk_bf16_f32 v67, v26, v27
    v_pk_mul_f32 v[56:57], v[54:55], v[42:43] op_sel:[0,0] op_sel_hi:[0,1]
    v_pk_fma_f32 v[30:31], v[28:29], v[40:41], v[30:31] op_sel:[1,1,0] op_sel_hi:[1,0,1] neg_lo:[0,1,0]
    ds_write_b32 v12, v67 offset:1360
    v_pk_fma_f32 v[56:57], v[54:55], v[42:43], v[56:57] op_sel:[1,1,0] op_sel_hi:[1,0,1] neg_lo:[0,1,0]
    v_cvt_pk_bf16_f32 v65, v30, v31
    v_pk_mul_f32 v[24:25], v[26:27], v[40:41] op_sel:[0,0] op_sel_hi:[0,1]
    v_cvt_pk_bf16_f32 v68, v56, v57
    ds_write_b32 v12, v65 offset:3536
    v_pk_fma_f32 v[24:25], v[26:27], v[40:41], v[24:25] op_sel:[1,1,0] op_sel_hi:[1,0,1] neg_lo:[0,1,0]
    ds_write_b32 v12, v68 offset:5984
    v_pk_mul_f32 v[28:29], v[30:31], v[40:41] op_sel:[0,0] op_sel_hi:[0,1]
    v_cvt_pk_bf16_f32 v66, v24, v25
    v_pk_mul_f32 v[58:59], v[56:57], v[42:43] op_sel:[0,0] op_sel_hi:[0,1]
    v_pk_fma_f32 v[28:29], v[30:31], v[40:41], v[28:29] op_sel:[1,1,0] op_sel_hi:[1,0,1] neg_lo:[0,1,0]
    ds_write_b32 v12, v66 offset:1632
    v_pk_fma_f32 v[58:59], v[56:57], v[42:43], v[58:59] op_sel:[1,1,0] op_sel_hi:[1,0,1] neg_lo:[0,1,0]
    v_cvt_pk_bf16_f32 v64, v28, v29
    v_pk_mul_f32 v[26:27], v[24:25], v[40:41] op_sel:[0,0] op_sel_hi:[0,1]
    v_cvt_pk_bf16_f32 v69, v58, v59
    ds_write_b32 v12, v64 offset:3808
    v_pk_fma_f32 v[26:27], v[24:25], v[40:41], v[26:27] op_sel:[1,1,0] op_sel_hi:[1,0,1] neg_lo:[0,1,0]
    ds_write_b32 v12, v69 offset:6256
    v_pk_mul_f32 v[30:31], v[28:29], v[40:41] op_sel:[0,0] op_sel_hi:[0,1]
    v_cvt_pk_bf16_f32 v67, v26, v27
    v_pk_fma_f32 v[30:31], v[28:29], v[40:41], v[30:31] op_sel:[1,1,0] op_sel_hi:[1,0,1] neg_lo:[0,1,0]
    ds_write_b32 v12, v67 offset:1904
    v_cvt_pk_bf16_f32 v65, v30, v31
    ds_write_b32 v12, v65 offset:4080
    v_pk_mul_f32 v[60:61], v[42:43], v[44:45] op_sel:[0,0] op_sel_hi:[0,1]
    v_pk_mul_f32 v[62:63], v[48:49], v[44:45] op_sel:[0,0] op_sel_hi:[0,1]
    v_pk_fma_f32 v[60:61], v[42:43], v[44:45], v[60:61] op_sel:[1,1,0] op_sel_hi:[1,0,1] neg_lo:[0,1,0]
    v_pk_fma_f32 v[62:63], v[48:49], v[44:45], v[62:63] op_sel:[1,1,0] op_sel_hi:[1,0,1] neg_lo:[0,1,0]
    v_cvt_pk_bf16_f32 v64, v60, v61
    v_cvt_pk_bf16_f32 v66, v62, v63
    ds_write_b32 v12, v64 offset:6800
    ds_write_b32 v12, v66 offset:7072
    v_pk_mul_f32 v[60:61], v[50:51], v[44:45] op_sel:[0,0] op_sel_hi:[0,1]
    v_pk_mul_f32 v[62:63], v[52:53], v[44:45] op_sel:[0,0] op_sel_hi:[0,1]
    v_pk_fma_f32 v[60:61], v[50:51], v[44:45], v[60:61] op_sel:[1,1,0] op_sel_hi:[1,0,1] neg_lo:[0,1,0]
    v_pk_fma_f32 v[62:63], v[52:53], v[44:45], v[62:63] op_sel:[1,1,0] op_sel_hi:[1,0,1] neg_lo:[0,1,0]
    v_cvt_pk_bf16_f32 v65, v60, v61
    v_cvt_pk_bf16_f32 v67, v62, v63
    ds_write_b32 v12, v65 offset:7344
    ds_write_b32 v12, v67 offset:7616
    v_pk_mul_f32 v[60:61], v[54:55], v[44:45] op_sel:[0,0] op_sel_hi:[0,1]
    v_pk_mul_f32 v[62:63], v[56:57], v[44:45] op_sel:[0,0] op_sel_hi:[0,1]
    v_pk_fma_f32 v[60:61], v[54:55], v[44:45], v[60:61] op_sel:[1,1,0] op_sel_hi:[1,0,1] neg_lo:[0,1,0]
    v_pk_fma_f32 v[62:63], v[56:57], v[44:45], v[62:63] op_sel:[1,1,0] op_sel_hi:[1,0,1] neg_lo:[0,1,0]
    v_cvt_pk_bf16_f32 v64, v60, v61
    v_cvt_pk_bf16_f32 v66, v62, v63
    ds_write_b32 v12, v64 offset:7888
    ds_write_b32 v12, v66 offset:8160
    v_pk_mul_f32 v[60:61], v[58:59], v[44:45] op_sel:[0,0] op_sel_hi:[0,1]
    v_pk_fma_f32 v[60:61], v[58:59], v[44:45], v[60:61] op_sel:[1,1,0] op_sel_hi:[1,0,1] neg_lo:[0,1,0]
    v_cvt_pk_bf16_f32 v65, v60, v61
    ds_write_b32 v12, v65 offset:8432
    s_branch L_AXC
L_AXB:
    s_lshl_b32 s55, s59, s85
    s_and_b32 s55, s55, 0xffff0000
    v_lshlrev_b32 v16, s84, v240
    v_lshlrev_b32 v17, s84, v241
    v_lshlrev_b32 v18, s84, v242
    v_lshlrev_b32 v19, s84, v243
    v_and_b32 v16, 0xffff0000, v16
    v_and_b32 v17, 0xffff0000, v17
    v_and_b32 v18, 0xffff0000, v18
    v_and_b32 v19, 0xffff0000, v19
    v_mov_b32 v20, 0x3fb8aa3b
    v_mul_f32 v20, s55, v20
    v_mul_f32 v21, 0x3fb8aa3b, v16
    v_exp_f32 v20, v20
    v_exp_f32 v21, v21
    s_nop 0
    v_cvt_pk_bf16_f32 v20, v20, v20
    v_lshlrev_b32 v20, 16, v20
    v_cvt_pk_bf16_f32 v21, v21, v21
    v_lshlrev_b32 v21, 16, v21
    v_mul_f32 v21, v21, v20
    v_mul_f32 v22, v17, v20
    v_mul_f32 v21, 0xbfb8aa3b, v21
    v_mul_f32 v22, 0x3e22f983, v22
    v_mul_f32 v24, 2.0, v21
    v_mul_f32 v25, 2.0, v22
    v_mul_f32 v26, 0x43000000, v21
    v_mul_f32 v27, 0x43000000, v22
    v_mul_f32 v28, 0x44800000, v21
    v_mul_f32 v29, 0x44800000, v22
    v_exp_f32 v24, v24
    v_fract_f32 v25, v25
    v_exp_f32 v26, v26
    v_fract_f32 v27, v27
    v_exp_f32 v28, v28
    v_fract_f32 v29, v29
    v_cos_f32 v30, v25
    v_sin_f32 v31, v25
    v_cos_f32 v32, v27
    v_sin_f32 v33, v27
    v_cos_f32 v34, v29
    v_sin_f32 v35, v29
    s_nop 0
    v_mul_f32 v30, v30, v24
    v_mul_f32 v31, v31, v24
    v_mul_f32 v32, v32, v26
    v_mul_f32 v33, v33, v26
    v_mul_f32 v34, v34, v28
    v_mul_f32 v35, v35, v28
    v_pk_mul_f32 v[40:41], v[32:33], v[32:33] op_sel:[0,0] op_sel_hi:[0,1]
    v_cvt_pk_bf16_f32 v74, v34, v35
    v_pk_mul_f32 v[36:37], v[30:31], v[30:31] op_sel:[0,0] op_sel_hi:[0,1]
    v_pk_fma_f32 v[40:41], v[32:33], v[32:33], v[40:41] op_sel:[1,1,0] op_sel_hi:[1,0,1] neg_lo:[0,1,0]
    ds_write_b32 v12, v74 offset:13056
    v_pk_fma_f32 v[36:37], v[30:31], v[30:31], v[36:37] op_sel:[1,1,0] op_sel_hi:[1,0,1] neg_lo:[0,1,0]
    v_cvt_pk_bf16_f32 v72, v40, v41
    v_pk_mul_f32 v[52:53], v[34:35], v[32:33] op_sel:[0,0] op_sel_hi:[0,1]
    v_pk_mul_f32 v[38:39], v[36:37], v[30:31] op_sel:[0,0] op_sel_hi:[0,1]
    ds_write_b32 v12, v72 offset:8704
    v_pk_fma_f32 v[52:53], v[34:35], v[32:33], v[52:53] op_sel:[1,1,0] op_sel_hi:[1,0,1] neg_lo:[0,1,0]
    v_pk_fma_f32 v[38:39], v[36:37], v[30:31], v[38:39] op_sel:[1,1,0] op_sel_hi:[1,0,1] neg_lo:[0,1,0]
    v_pk_mul_f32 v[42:43], v[40:41], v[32:33] op_sel:[0,0] op_sel_hi:[0,1]
    v_cvt_pk_bf16_f32 v75, v52, v53
    v_pk_fma_f32 v[42:43], v[40:41], v[32:33], v[42:43] op_sel:[1,1,0] op_sel_hi:[1,0,1] neg_lo:[0,1,0]
    ds_write_b32 v12, v75 offset:13328
    v_cvt_pk_bf16_f32 v73, v42, v43
    v_pk_mul_f32 v[54:55], v[52:53], v[32:33] op_sel:[0,0] op_sel_hi:[0,1]
    ds_write_b32 v12, v73 offset:9792
    v_pk_fma_f32 v[54:55], v[52:53], v[32:33], v[54:55] op_sel:[1,1,0] op_sel_hi:[1,0,1] neg_lo:[0,1,0]
    v_pk_mul_f32 v[44:45], v[42:43], v[32:33] op_sel:[0,0] op_sel_hi:[0,1]
    v_cvt_pk_bf16_f32 v74, v54, v55
    v_pk_fma_f32 v[44:45], v[42:43], v[32:33], v[44:45] op_sel:[1,1,0] op_sel_hi:[1,0,1] neg_lo:[0,1,0]
    ds_write_b32 v12, v74 offset:13600
    v_cvt_pk_bf16_f32 v72, v44, v45
    v_pk_mul_f32 v[56:57], v[54:55], v[32:33] op_sel:[0,0] op_sel_hi:[0,1]
    ds_write_b32 v12, v72 offset:10880
    v_pk_fma_f32 v[56:57], v[54:55], v[32:33], v[56:57] op_sel:[1,1,0] op_sel_hi:[1,0,1] neg_lo:[0,1,0]
    v_pk_mul_f32 v[46:47], v[44:45], v[32:33] op_sel:[0,0] op_sel_hi:[0,1]
    v_cvt_pk_bf16_f32 v75, v56, v57
    v_pk_fma_f32 v[46:47], v[44:45], v[32:33], v[46:47] op_sel:[1,1,0] op_sel_hi:[1,0,1] neg_lo:[0,1,0]
    ds_write_b32 v12, v75 offset:13872
    v_cvt_pk_bf16_f32 v73, v46, v47
    v_pk_mul_f32 v[58:59], v[56:57], v[32:33] op_sel:[0,0] op_sel_hi:[0,1]
    ds_write_b32 v12, v73 offset:11152
    v_pk_fma_f32 v[58:59], v[56:57], v[32:33], v[58:59] op_sel:[1,1,0] op_sel_hi:[1,0,1] neg_lo:[0,1,0]
    v_pk_mul_f32 v[48:49], v[46:47], v[32:33] op_sel:[0,0] op_sel_hi:[0,1]
    v_cvt_pk_bf16_f32 v74, v58, v59
    v_pk_fma_f32 v[48:49], v[46:47], v[32:33], v[48:49] op_sel:[1,1,0] op_sel_hi:[1,0,1] neg_lo:[0,1,0]
    ds_write_b32 v12, v74 offset:14144
    v_cvt_pk_bf16_f32 v72, v48, v49
    v_pk_mul_f32 v[60:61], v[58:59], v[32:33] op_sel:[0,0] op_sel_hi:[0,1]
    ds_write_b32 v12, v72 offset:11424
    v_pk_fma_f32 v[60:61], v[58:59], v[32:33], v[60:61] op_sel:[1,1,0] op_sel_hi:[1,0,1] neg_lo:[0,1,0]
    v_pk_mul_f32 v[50:51], v[48:49], v[32:33] op_sel:[0,0] op_sel_hi:[0,1]
    v_cvt_pk_bf16_f32 v75, v60, v61
    v_pk_fma_f32 v[50:51], v[48:49], v[32:33], v[50:51] op_sel:[1,1,0] op_sel_hi:[1,0,1] neg_lo:[0,1,0]
    ds_write_b32 v12, v75 offset:14416
    v_cvt_pk_bf16_f32 v73, v50, v51
    v_pk_mul_f32 v[62:63], v[60:61], v[32:33] op_sel:[0,0] op_sel_hi:[0,1]
    ds_write_b32 v12, v73 offset:11696
    v_pk_fma_f32 v[62:63], v[60:61], v[32:33], v[62:63] op_sel:[1,1,0] op_sel_hi:[1,0,1] neg_lo:[0,1,0]
    v_cvt_pk_bf16_f32 v74, v62, v63
    ds_write_b32 v12, v74 offset:14688
    v_pk_mul_f32 v[64:65], v[62:63], v[32:33] op_sel:[0,0] op_sel_hi:[0,1]
    v_pk_fma_f32 v[64:65], v[62:63], v[32:33], v[64:65] op_sel:[1,1,0] op_sel_hi:[1,0,1] neg_lo:[0,1,0]
    v_cvt_pk_bf16_f32 v75, v64, v65
    ds_write_b32 v12, v75 offset:14960
    v_pk_mul_f32 v[66:67], v[64:65], v[32:33] op_sel:[0,0] op_sel_hi:[0,1]
    v_pk_fma_f32 v[66:67], v[64:65], v[32:33], v[66:67] op_sel:[1,1,0] op_sel_hi:[1,0,1] neg_lo:[0,1,0]
    v_cvt_pk_bf16_f32 v74, v66, v67
    ds_write_b32 v12, v74 offset:15232
    v_pk_mul_f32 v[68:69], v[30:31], v[40:41] op_sel:[0,0] op_sel_hi:[0,1]
    v_pk_mul_f32 v[70:71], v[36:37], v[40:41] op_sel:[0,0] op_sel_hi:[0,1]
    v_pk_fma_f32 v[68:69], v[30:31], v[40:41], v[68:69] op_sel:[1,1,0] op_sel_hi:[1,0,1] neg_lo:[0,1,0]
    v_pk_fma_f32 v[70:71], v[36:37], v[40:41], v[70:71] op_sel:[1,1,0] op_sel_hi:[1,0,1] neg_lo:[0,1,0]
    v_cvt_pk_bf16_f32 v72, v68, v69
    v_cvt_pk_bf16_f32 v75, v70, v71
    ds_write_b32 v12, v72 offset:8976
    ds_write_b32 v12, v75 offset:9248
    v_pk_mul_f32 v[68:69], v[38:39], v[40:41] op_sel:[0,0] op_sel_hi:[0,1]
    v_pk_mul_f32 v[70:71], v[30:31], v[42:43] op_sel:[0,0] op_sel_hi:[0,1]
    v_pk_fma_f32 v[68:69], v[38:39], v[40:41], v[68:69] op_sel:[1,1,0] op_sel_hi:[1,0,1] neg_lo:[0,1,0]
    v_pk_fma_f32 v[70:71], v[30:31], v[42:43], v[70:71] op_sel:[1,1,0] op_sel_hi:[1,0,1] neg_lo:[0,1,0]
    v_cvt_pk_bf16_f32 v73, v68, v69
    v_cvt_pk_bf16_f32 v74, v70, v71
    ds_write_b32 v12, v73 offset:9520
    ds_write_b32 v12, v74 offset:10064
    v_pk_mul_f32 v[68:69], v[36:37], v[42:43] op_sel:[0,0] op_sel_hi:[0,1]
    v_pk_mul_f32 v[70:71], v[38:39], v[42:43] op_sel:[0,0] op_sel_hi:[0,1]
    v_pk_fma_f32 v[68:69], v[36:37], v[42:43], v[68:69] op_sel:[1,1,0] op_sel_hi:[1,0,1] neg_lo:[0,1,0]
    v_pk_fma_f32 v[70:71], v[38:39], v[42:43], v[70:71] op_sel:[1,1,0] op_sel_hi:[1,0,1] neg_lo:[0,1,0]
    v_cvt_pk_bf16_f32 v72, v68, v69
    v_cvt_pk_bf16_f32 v75, v70, v71
    ds_write_b32 v12, v72 offset:10336
    ds_write_b32 v12, v75 offset:10608
    v_pk_mul_f32 v[68:69], v[36:37], v[44:45] op_sel:[0,0] op_sel_hi:[0,1]
    v_pk_mul_f32 v[70:71], v[36:37], v[46:47] op_sel:[0,0] op_sel_hi:[0,1]
    v_pk_fma_f32 v[68:69], v[36:37], v[44:45], v[68:69] op_sel:[1,1,0] op_sel_hi:[1,0,1] neg_lo:[0,1,0]
    v_pk_fma_f32 v[70:71], v[36:37], v[46:47], v[70:71] op_sel:[1,1,0] op_sel_hi:[1,0,1] neg_lo:[0,1,0]
    v_cvt_pk_bf16_f32 v73, v68, v69
    v_cvt_pk_bf16_f32 v74, v70, v71
    ds_write_b32 v12, v73 offset:11968
    ds_write_b32 v12, v74 offset:12240
    v_pk_mul_f32 v[68:69], v[36:37], v[48:49] op_sel:[0,0] op_sel_hi:[0,1]
    v_pk_mul_f32 v[70:71], v[36:37], v[50:51] op_sel:[0,0] op_sel_hi:[0,1]
    v_pk_fma_f32 v[68:69], v[36:37], v[48:49], v[68:69] op_sel:[1,1,0] op_sel_hi:[1,0,1] neg_lo:[0,1,0]
    v_pk_fma_f32 v[70:71], v[36:37], v[50:51], v[70:71] op_sel:[1,1,0] op_sel_hi:[1,0,1] neg_lo:[0,1,0]
    v_cvt_pk_bf16_f32 v72, v68, v69
    v_cvt_pk_bf16_f32 v75, v70, v71
    ds_write_b32 v12, v72 offset:12512
    ds_write_b32 v12, v75 offset:12784
    v_and_b32 v13, 15, v1
    v_lshrrev_b32 v14, 4, v1
    v_mul_u32_u24 v198, 272, v13
    v_lshl_add_u32 v198, v14, 4, v198
    s_bitcmp1_b32 s32, 1
    s_mov_b32 s53, 114688
    s_cmov_b32 s53, 32768
    s_mov_b32 s54, 130192
    s_cmov_b32 s54, 145696
    v_add_u32 v199, s54, v198
    v_add_u32 v198, s53, v198
    s_and_b32 s53, s32, 1
    s_mul_i32 s53, s53, 8704
    v_add_u32 v235, s53, v198
    v_add_u32 v236, s53, v199
L_AXC:
    s_mul_i32 s71, s32, 229376
    s_lshl_b32 s53, s58, 7
    s_add_u32 s71, s71, s53
    s_lshl_b32 s72, s32, 12
    s_lshl_b32 s77, s57, 16
    s_add_u32 s77, s77, s53
    s_lshl_b32 s54, s32, 13
    s_add_u32 s77, s77, s54
    s_lshr_b32 s53, s2, 2
    s_and_b32 s53, s53, 6
    s_and_b32 s54, s2, 7
    s_add_u32 s53, s53, s54
    s_sub_u32 s54, s53, 7
    s_cmp_ge_u32 s53, 7
    s_cselect_b32 s53, s54, s53
    s_lshl_b32 s64, s53, 10
    s_add_u32 s53, s53, 1
    s_sub_u32 s54, s53, 7
    s_cmp_ge_u32 s53, 7
    s_cselect_b32 s53, s54, s53
    s_lshl_b32 s65, s53, 10
    s_add_u32 s53, s53, 1
    s_sub_u32 s54, s53, 7
    s_cmp_ge_u32 s53, 7
    s_cselect_b32 s53, s54, s53
    s_lshl_b32 s66, s53, 10
    s_add_u32 s53, s53, 1
    s_sub_u32 s54, s53, 7
    s_cmp_ge_u32 s53, 7
    s_cselect_b32 s53, s54, s53
    s_lshl_b32 s67, s53, 10
    s_add_u32 s53, s53, 1
    s_sub_u32 s54, s53, 7
    s_cmp_ge_u32 s53, 7
    s_cselect_b32 s53, s54, s53
    s_lshl_b32 s68, s53, 10
    s_add_u32 s53, s53, 1
    s_sub_u32 s54, s53, 7
    s_cmp_ge_u32 s53, 7
    s_cselect_b32 s53, s54, s53
    s_lshl_b32 s69, s53, 10
    s_add_u32 s53, s53, 1
    s_sub_u32 s54, s53, 7
    s_cmp_ge_u32 s53, 7
    s_cselect_b32 s53, s54, s53
    s_lshl_b32 s70, s53, 10
    s_mul_i32 s53, s57, 224
    s_mul_i32 s54, s32, 7
    s_add_u32 s53, s53, s54
    s_lshl_b32 s53, s53, 10
    s_add_u32 s53, s53, 4194304
    s_add_u32 s73, s58, 0
    s_and_b32 s73, s73, 3
    s_mul_i32 s73, s73, 57344
    s_add_u32 s73, s73, s53
    s_add_u32 s74, s58, 1
    s_and_b32 s74, s74, 3
    s_mul_i32 s74, s74, 57344
    s_add_u32 s74, s74, s53
    s_add_u32 s75, s58, 2
    s_and_b32 s75, s75, 3
    s_mul_i32 s75, s75, 57344
    s_add_u32 s75, s75, s53
    s_add_u32 s76, s58, 3
    s_and_b32 s76, s76, 3
    s_mul_i32 s76, s76, 57344
    s_add_u32 s76, s76, s53
    v_lshrrev_b32 v13, 4, v1
    v_lshlrev_b32 v13, 1, v13
    v_xor_b32 v13, v13, v1
    v_and_b32 v13, 7, v13
    v_lshrrev_b32 v14, 3, v1
    v_lshlrev_b32 v244, 10, v14
    v_lshl_add_u32 v244, v13, 4, v244
    v_and_b32 v14, 3, v14
    v_lshlrev_b32 v14, 5, v14
    v_lshrrev_b32 v13, 2, v1
    v_lshl_add_u32 v14, v13, 7, v14
    v_and_b32 v249, 3, v1
    v_lshl_add_u32 v14, v249, 3, v14
    v_add_u32 v245, s72, v14
    v_xor_b32 v246, 32, v245
    v_xor_b32 v247, 64, v245
    v_xor_b32 v248, 96, v245
    v_lshl_add_u32 v13, v249, 2, v13
    v_and_b32 v13, 15, v13
    v_lshl_add_u32 v13, v249, 4, v13
    s_lshl_b32 s53, s32, 10
    s_add_u32 s53, s53, 65536
    v_lshl_add_u32 v249, v13, 4, s53
    v_lshlrev_b32 v250, 3, v0
    v_add_u32 v250, 148480, v250
    v_mov_b32 v152, 0x3f803f80
    v_and_b32 v3, 7, v1
    v_xor_b32 v3, s32, v3
    v_lshlrev_b32 v3, 4, v3
    v_lshl_add_u32 v3, v1, 10, v3
    v_add_u32 v3, 49152, v3
    v_lshrrev_b32 v4, 4, v1
    v_lshlrev_b32 v4, 5, v4
    s_lshr_b32 s53, s34, 6
    s_add_u32 s53, s53, 3145728
    s_mov_b32 s60, 0x00010001
    s_mov_b32 s61, 0x00010001
    s_waitcnt vmcnt(0)
    s_cmp_lg_u32 s32, 4
    s_cbranch_scc1 W0_20
    buffer_load_dword v9, off, s[24:27], 0 sc1
W0_20:
    v_dot2_f32_bf16 v144, v112, v152, 0
    v_dot2_f32_bf16 v145, v116, v152, 0
    v_dot2_f32_bf16 v146, v120, v152, 0
    v_dot2_f32_bf16 v147, v124, v152, 0
    v_dot2_f32_bf16 v148, v128, v152, 0
    v_dot2_f32_bf16 v149, v132, v152, 0
    v_dot2_f32_bf16 v150, v136, v152, 0
    v_dot2_f32_bf16 v151, v140, v152, 0
    v_dot2_f32_bf16 v144, v113, v152, v144
    v_dot2_f32_bf16 v145, v117, v152, v145
    v_dot2_f32_bf16 v146, v121, v152, v146
    v_dot2_f32_bf16 v147, v125, v152, v147
    v_dot2_f32_bf16 v148, v129, v152, v148
    v_dot2_f32_bf16 v149, v133, v152, v149
    v_dot2_f32_bf16 v150, v137, v152, v150
    v_dot2_f32_bf16 v151, v141, v152, v151
    v_dot2_f32_bf16 v144, v114, v152, v144
    v_dot2_f32_bf16 v145, v118, v152, v145
    v_dot2_f32_bf16 v146, v122, v152, v146
    v_dot2_f32_bf16 v147, v126, v152, v147
    v_dot2_f32_bf16 v148, v130, v152, v148
    v_dot2_f32_bf16 v149, v134, v152, v149
    v_dot2_f32_bf16 v150, v138, v152, v150
    v_dot2_f32_bf16 v151, v142, v152, v151
    v_dot2_f32_bf16 v144, v115, v152, v144
    v_dot2_f32_bf16 v145, v119, v152, v145
    v_dot2_f32_bf16 v146, v123, v152, v146
    v_dot2_f32_bf16 v147, v127, v152, v147
    v_dot2_f32_bf16 v148, v131, v152, v148
    v_dot2_f32_bf16 v149, v135, v152, v149
    v_dot2_f32_bf16 v150, v139, v152, v150
    v_dot2_f32_bf16 v151, v143, v152, v151
    v_lshlrev_b32 v16, 16, v112
    v_and_b32 v17, 0xffff0000, v112
    v_lshlrev_b32 v18, 16, v113
    v_and_b32 v19, 0xffff0000, v113
    v_lshlrev_b32 v20, 16, v114
    v_and_b32 v21, 0xffff0000, v114
    v_lshlrev_b32 v22, 16, v115
    v_and_b32 v23, 0xffff0000, v115
    v_lshlrev_b32 v24, 16, v116
    v_and_b32 v25, 0xffff0000, v116
    v_lshlrev_b32 v26, 16, v117
    v_and_b32 v27, 0xffff0000, v117
    v_lshlrev_b32 v28, 16, v118
    v_and_b32 v29, 0xffff0000, v118
    v_lshlrev_b32 v30, 16, v119
    v_and_b32 v31, 0xffff0000, v119
    v_lshlrev_b32 v32, 16, v120
    v_and_b32 v33, 0xffff0000, v120
    v_lshlrev_b32 v34, 16, v121
    v_and_b32 v35, 0xffff0000, v121
    v_lshlrev_b32 v36, 16, v122
    v_and_b32 v37, 0xffff0000, v122
    v_lshlrev_b32 v38, 16, v123
    v_and_b32 v39, 0xffff0000, v123
    v_lshlrev_b32 v40, 16, v124
    v_and_b32 v41, 0xffff0000, v124
    v_lshlrev_b32 v42, 16, v125
    v_and_b32 v43, 0xffff0000, v125
    v_lshlrev_b32 v44, 16, v126
    v_and_b32 v45, 0xffff0000, v126
    v_lshlrev_b32 v46, 16, v127
    v_and_b32 v47, 0xffff0000, v127
    v_lshlrev_b32 v48, 16, v128
    v_and_b32 v49, 0xffff0000, v128
    v_lshlrev_b32 v50, 16, v129
    v_and_b32 v51, 0xffff0000, v129
    v_lshlrev_b32 v52, 16, v130
    v_and_b32 v53, 0xffff0000, v130
    v_lshlrev_b32 v54, 16, v131
    v_and_b32 v55, 0xffff0000, v131
    v_lshlrev_b32 v56, 16, v132
    v_and_b32 v57, 0xffff0000, v132
    v_lshlrev_b32 v58, 16, v133
    v_and_b32 v59, 0xffff0000, v133
    v_lshlrev_b32 v60, 16, v134
    v_and_b32 v61, 0xffff0000, v134
    v_lshlrev_b32 v62, 16, v135
    v_and_b32 v63, 0xffff0000, v135
    v_lshlrev_b32 v64, 16, v136
    v_and_b32 v65, 0xffff0000, v136
    v_lshlrev_b32 v66, 16, v137
    v_and_b32 v67, 0xffff0000, v137
    v_lshlrev_b32 v68, 16, v138
    v_and_b32 v69, 0xffff0000, v138
    v_lshlrev_b32 v70, 16, v139
    v_and_b32 v71, 0xffff0000, v139
    v_lshlrev_b32 v72, 16, v140
    v_and_b32 v73, 0xffff0000, v140
    v_lshlrev_b32 v74, 16, v141
    v_and_b32 v75, 0xffff0000, v141
    v_lshlrev_b32 v76, 16, v142
    v_and_b32 v77, 0xffff0000, v142
    v_lshlrev_b32 v78, 16, v143
    v_and_b32 v79, 0xffff0000, v143
    s_nop 1
    v_permlane32_swap_b32 v144, v148
    v_permlane32_swap_b32 v145, v149
    v_permlane32_swap_b32 v146, v150
    v_permlane32_swap_b32 v147, v151
    s_nop 1
    v_add_f32 v144, v144, v148
    v_add_f32 v145, v145, v149
    v_add_f32 v146, v146, v150
    v_add_f32 v147, v147, v151
    s_nop 1
    v_permlane16_swap_b32 v144, v146
    v_permlane16_swap_b32 v145, v147
    s_nop 1
    v_add_f32 v144, v144, v146
    v_add_f32 v145, v145, v147
    s_nop 1
    v_add_f32_dpp v144, v144, v144 row_ror:8 row_mask:0xf bank_mask:0xf
    v_add_f32_dpp v145, v145, v145 row_ror:8 row_mask:0xf bank_mask:0xf
    s_nop 1
    v_add_f32_dpp v144, v144, v144 row_ror:4 row_mask:0xf bank_mask:0xf
    v_add_f32_dpp v145, v145, v145 row_ror:4 row_mask:0xf bank_mask:0xf
    s_nop 1
    v_add_f32_dpp v144, v144, v144 row_ror:2 row_mask:0xf bank_mask:0xf
    v_add_f32_dpp v145, v145, v145 row_ror:2 row_mask:0xf bank_mask:0xf
    s_nop 1
    v_add_f32_dpp v144, v144, v144 row_ror:1 row_mask:0xf bank_mask:0xf
    v_add_f32_dpp v145, v145, v145 row_ror:1 row_mask:0xf bank_mask:0xf
    v_mul_f32 v154, 0x3b000000, v144
    v_mul_f32 v155, 0x3b000000, v145
    s_nop 0
    v_readlane_b32 s36, v154, 0
    v_readlane_b32 s38, v155, 0
    v_readlane_b32 s40, v154, 16
    v_readlane_b32 s42, v155, 16
    v_readlane_b32 s44, v154, 32
    v_readlane_b32 s46, v155, 32
    v_readlane_b32 s48, v154, 48
    v_readlane_b32 s50, v155, 48
    s_nop 1
    v_pk_add_f32 v[80:81], v[16:17], s[36:37] op_sel_hi:[1,0] neg_lo:[0,1] neg_hi:[0,1]
    v_pk_add_f32 v[82:83], v[24:25], s[38:39] op_sel_hi:[1,0] neg_lo:[0,1] neg_hi:[0,1]
    v_pk_add_f32 v[84:85], v[32:33], s[40:41] op_sel_hi:[1,0] neg_lo:[0,1] neg_hi:[0,1]
    v_pk_add_f32 v[86:87], v[40:41], s[42:43] op_sel_hi:[1,0] neg_lo:[0,1] neg_hi:[0,1]
    v_pk_add_f32 v[88:89], v[48:49], s[44:45] op_sel_hi:[1,0] neg_lo:[0,1] neg_hi:[0,1]
    v_pk_add_f32 v[90:91], v[56:57], s[46:47] op_sel_hi:[1,0] neg_lo:[0,1] neg_hi:[0,1]
    v_pk_add_f32 v[92:93], v[64:65], s[48:49] op_sel_hi:[1,0] neg_lo:[0,1] neg_hi:[0,1]
    v_pk_add_f32 v[94:95], v[72:73], s[50:51] op_sel_hi:[1,0] neg_lo:[0,1] neg_hi:[0,1]
    v_pk_mul_f32 v[112:113], v[80:81], v[80:81]
    v_pk_mul_f32 v[114:115], v[82:83], v[82:83]
    v_pk_mul_f32 v[116:117], v[84:85], v[84:85]
    v_pk_mul_f32 v[118:119], v[86:87], v[86:87]
    v_pk_mul_f32 v[120:121], v[88:89], v[88:89]
    v_pk_mul_f32 v[122:123], v[90:91], v[90:91]
    v_pk_mul_f32 v[124:125], v[92:93], v[92:93]
    v_pk_mul_f32 v[126:127], v[94:95], v[94:95]
    v_pk_add_f32 v[80:81], v[18:19], s[36:37] op_sel_hi:[1,0] neg_lo:[0,1] neg_hi:[0,1]
    v_pk_add_f32 v[82:83], v[26:27], s[38:39] op_sel_hi:[1,0] neg_lo:[0,1] neg_hi:[0,1]
    v_pk_add_f32 v[84:85], v[34:35], s[40:41] op_sel_hi:[1,0] neg_lo:[0,1] neg_hi:[0,1]
    v_pk_add_f32 v[86:87], v[42:43], s[42:43] op_sel_hi:[1,0] neg_lo:[0,1] neg_hi:[0,1]
    v_pk_add_f32 v[88:89], v[50:51], s[44:45] op_sel_hi:[1,0] neg_lo:[0,1] neg_hi:[0,1]
    v_pk_add_f32 v[90:91], v[58:59], s[46:47] op_sel_hi:[1,0] neg_lo:[0,1] neg_hi:[0,1]
    v_pk_add_f32 v[92:93], v[66:67], s[48:49] op_sel_hi:[1,0] neg_lo:[0,1] neg_hi:[0,1]
    v_pk_add_f32 v[94:95], v[74:75], s[50:51] op_sel_hi:[1,0] neg_lo:[0,1] neg_hi:[0,1]
    v_pk_fma_f32 v[112:113], v[80:81], v[80:81], v[112:113]
    v_pk_fma_f32 v[114:115], v[82:83], v[82:83], v[114:115]
    v_pk_fma_f32 v[116:117], v[84:85], v[84:85], v[116:117]
    v_pk_fma_f32 v[118:119], v[86:87], v[86:87], v[118:119]
    v_pk_fma_f32 v[120:121], v[88:89], v[88:89], v[120:121]
    v_pk_fma_f32 v[122:123], v[90:91], v[90:91], v[122:123]
    v_pk_fma_f32 v[124:125], v[92:93], v[92:93], v[124:125]
    v_pk_fma_f32 v[126:127], v[94:95], v[94:95], v[126:127]
    v_pk_add_f32 v[80:81], v[20:21], s[36:37] op_sel_hi:[1,0] neg_lo:[0,1] neg_hi:[0,1]
    v_pk_add_f32 v[82:83], v[28:29], s[38:39] op_sel_hi:[1,0] neg_lo:[0,1] neg_hi:[0,1]
    v_pk_add_f32 v[84:85], v[36:37], s[40:41] op_sel_hi:[1,0] neg_lo:[0,1] neg_hi:[0,1]
    v_pk_add_f32 v[86:87], v[44:45], s[42:43] op_sel_hi:[1,0] neg_lo:[0,1] neg_hi:[0,1]
    v_pk_add_f32 v[88:89], v[52:53], s[44:45] op_sel_hi:[1,0] neg_lo:[0,1] neg_hi:[0,1]
    v_pk_add_f32 v[90:91], v[60:61], s[46:47] op_sel_hi:[1,0] neg_lo:[0,1] neg_hi:[0,1]
    v_pk_add_f32 v[92:93], v[68:69], s[48:49] op_sel_hi:[1,0] neg_lo:[0,1] neg_hi:[0,1]
    v_pk_add_f32 v[94:95], v[76:77], s[50:51] op_sel_hi:[1,0] neg_lo:[0,1] neg_hi:[0,1]
    v_pk_fma_f32 v[112:113], v[80:81], v[80:81], v[112:113]
    v_pk_fma_f32 v[114:115], v[82:83], v[82:83], v[114:115]
    v_pk_fma_f32 v[116:117], v[84:85], v[84:85], v[116:117]
    v_pk_fma_f32 v[118:119], v[86:87], v[86:87], v[118:119]
    v_pk_fma_f32 v[120:121], v[88:89], v[88:89], v[120:121]
    v_pk_fma_f32 v[122:123], v[90:91], v[90:91], v[122:123]
    v_pk_fma_f32 v[124:125], v[92:93], v[92:93], v[124:125]
    v_pk_fma_f32 v[126:127], v[94:95], v[94:95], v[126:127]
    v_pk_add_f32 v[80:81], v[22:23], s[36:37] op_sel_hi:[1,0] neg_lo:[0,1] neg_hi:[0,1]
    v_pk_add_f32 v[82:83], v[30:31], s[38:39] op_sel_hi:[1,0] neg_lo:[0,1] neg_hi:[0,1]
    v_pk_add_f32 v[84:85], v[38:39], s[40:41] op_sel_hi:[1,0] neg_lo:[0,1] neg_hi:[0,1]
    v_pk_add_f32 v[86:87], v[46:47], s[42:43] op_sel_hi:[1,0] neg_lo:[0,1] neg_hi:[0,1]
    v_pk_add_f32 v[88:89], v[54:55], s[44:45] op_sel_hi:[1,0] neg_lo:[0,1] neg_hi:[0,1]
    v_pk_add_f32 v[90:91], v[62:63], s[46:47] op_sel_hi:[1,0] neg_lo:[0,1] neg_hi:[0,1]
    v_pk_add_f32 v[92:93], v[70:71], s[48:49] op_sel_hi:[1,0] neg_lo:[0,1] neg_hi:[0,1]
    v_pk_add_f32 v[94:95], v[78:79], s[50:51] op_sel_hi:[1,0] neg_lo:[0,1] neg_hi:[0,1]
    v_pk_fma_f32 v[112:113], v[80:81], v[80:81], v[112:113]
    v_pk_fma_f32 v[114:115], v[82:83], v[82:83], v[114:115]
    v_pk_fma_f32 v[116:117], v[84:85], v[84:85], v[116:117]
    v_pk_fma_f32 v[118:119], v[86:87], v[86:87], v[118:119]
    v_pk_fma_f32 v[120:121], v[88:89], v[88:89], v[120:121]
    v_pk_fma_f32 v[122:123], v[90:91], v[90:91], v[122:123]
    v_pk_fma_f32 v[124:125], v[92:93], v[92:93], v[124:125]
    v_pk_fma_f32 v[126:127], v[94:95], v[94:95], v[126:127]
    v_add_f32 v144, v112, v113
    v_add_f32 v145, v114, v115
    v_add_f32 v146, v116, v117
    v_add_f32 v147, v118, v119
    v_add_f32 v148, v120, v121
    v_add_f32 v149, v122, v123
    v_add_f32 v150, v124, v125
    v_add_f32 v151, v126, v127
    s_nop 1
    v_permlane32_swap_b32 v144, v148
    v_permlane32_swap_b32 v145, v149
    v_permlane32_swap_b32 v146, v150
    v_permlane32_swap_b32 v147, v151
    s_nop 1
    v_add_f32 v144, v144, v148
    v_add_f32 v145, v145, v149
    v_add_f32 v146, v146, v150
    v_add_f32 v147, v147, v151
    s_nop 1
    v_permlane16_swap_b32 v144, v146
    v_permlane16_swap_b32 v145, v147
    s_nop 1
    v_add_f32 v144, v144, v146
    v_add_f32 v145, v145, v147
    s_nop 1
    v_add_f32_dpp v144, v144, v144 row_ror:8 row_mask:0xf bank_mask:0xf
    v_add_f32_dpp v145, v145, v145 row_ror:8 row_mask:0xf bank_mask:0xf
    s_nop 1
    v_add_f32_dpp v144, v144, v144 row_ror:4 row_mask:0xf bank_mask:0xf
    v_add_f32_dpp v145, v145, v145 row_ror:4 row_mask:0xf bank_mask:0xf
    s_nop 1
    v_add_f32_dpp v144, v144, v144 row_ror:2 row_mask:0xf bank_mask:0xf
    v_add_f32_dpp v145, v145, v145 row_ror:2 row_mask:0xf bank_mask:0xf
    s_nop 1
    v_add_f32_dpp v144, v144, v144 row_ror:1 row_mask:0xf bank_mask:0xf
    v_add_f32_dpp v145, v145, v145 row_ror:1 row_mask:0xf bank_mask:0xf
    v_mul_f32 v144, 0x3b000000, v144
    v_cvt_pk_bf16_f32 v144, v144, v144
    v_lshlrev_b32 v144, 16, v144
    v_add_f32 v144, 0x3727c5ac, v144
    v_cvt_pk_bf16_f32 v144, v144, v144
    v_lshlrev_b32 v144, 16, v144
    v_sqrt_f32 v144, v144
    s_nop 0
    v_cvt_pk_bf16_f32 v144, v144, v144
    v_lshlrev_b32 v144, 16, v144
    v_rcp_f32 v164, v144
    v_cvt_pk_bf16_f32 v156, v154, v154
    v_lshlrev_b32 v156, 16, v156
    v_mul_f32 v157, 0xbfb8aa3b, v164
    v_mul_f32 v158, v144, v144
    v_mov_b32 v159, v144
    v_mul_f32 v145, 0x3b000000, v145
    v_cvt_pk_bf16_f32 v145, v145, v145
    v_lshlrev_b32 v145, 16, v145
    v_add_f32 v145, 0x3727c5ac, v145
    v_cvt_pk_bf16_f32 v145, v145, v145
    v_lshlrev_b32 v145, 16, v145
    v_sqrt_f32 v145, v145
    s_nop 0
    v_cvt_pk_bf16_f32 v145, v145, v145
    v_lshlrev_b32 v145, 16, v145
    v_rcp_f32 v165, v145
    v_cvt_pk_bf16_f32 v160, v155, v155
    v_lshlrev_b32 v160, 16, v160
    v_mul_f32 v161, 0xbfb8aa3b, v165
    v_mul_f32 v162, v145, v145
    v_mov_b32 v163, v145
    s_nop 0
    v_readlane_b32 s36, v156, 0
    v_readlane_b32 s37, v164, 0
    v_readlane_b32 s38, v160, 0
    v_readlane_b32 s39, v165, 0
    v_readlane_b32 s40, v156, 16
    v_readlane_b32 s41, v164, 16
    v_readlane_b32 s42, v160, 16
    v_readlane_b32 s43, v165, 16
    v_readlane_b32 s44, v156, 32
    v_readlane_b32 s45, v164, 32
    v_readlane_b32 s46, v160, 32
    v_readlane_b32 s47, v165, 32
    v_readlane_b32 s48, v156, 48
    v_readlane_b32 s49, v164, 48
    v_readlane_b32 s50, v160, 48
    v_readlane_b32 s51, v165, 48
    s_mov_b64 exec, s[60:61]
    buffer_store_dwordx4 v[156:159], v4, s[28:31], s53 offen offset:0 sc1
    buffer_store_dwordx4 v[160:163], v4, s[28:31], s53 offen offset:16 sc1
    s_mov_b64 exec, -1
    v_pk_add_f32 v[16:17], v[16:17], s[36:37] op_sel_hi:[1,0] neg_lo:[0,1] neg_hi:[0,1]
    v_pk_add_f32 v[18:19], v[18:19], s[36:37] op_sel_hi:[1,0] neg_lo:[0,1] neg_hi:[0,1]
    v_pk_add_f32 v[20:21], v[20:21], s[36:37] op_sel_hi:[1,0] neg_lo:[0,1] neg_hi:[0,1]
    v_pk_add_f32 v[22:23], v[22:23], s[36:37] op_sel_hi:[1,0] neg_lo:[0,1] neg_hi:[0,1]
    v_pk_mul_f32 v[16:17], v[16:17], s[36:37] op_sel:[0,1] op_sel_hi:[1,1]
    v_pk_mul_f32 v[18:19], v[18:19], s[36:37] op_sel:[0,1] op_sel_hi:[1,1]
    v_pk_mul_f32 v[20:21], v[20:21], s[36:37] op_sel:[0,1] op_sel_hi:[1,1]
    v_pk_mul_f32 v[22:23], v[22:23], s[36:37] op_sel:[0,1] op_sel_hi:[1,1]
    v_pk_add_f32 v[24:25], v[24:25], s[38:39] op_sel_hi:[1,0] neg_lo:[0,1] neg_hi:[0,1]
    v_pk_add_f32 v[26:27], v[26:27], s[38:39] op_sel_hi:[1,0] neg_lo:[0,1] neg_hi:[0,1]
    v_pk_add_f32 v[28:29], v[28:29], s[38:39] op_sel_hi:[1,0] neg_lo:[0,1] neg_hi:[0,1]
    v_pk_add_f32 v[30:31], v[30:31], s[38:39] op_sel_hi:[1,0] neg_lo:[0,1] neg_hi:[0,1]
    v_pk_mul_f32 v[24:25], v[24:25], s[38:39] op_sel:[0,1] op_sel_hi:[1,1]
    v_pk_mul_f32 v[26:27], v[26:27], s[38:39] op_sel:[0,1] op_sel_hi:[1,1]
    v_pk_mul_f32 v[28:29], v[28:29], s[38:39] op_sel:[0,1] op_sel_hi:[1,1]
    v_pk_mul_f32 v[30:31], v[30:31], s[38:39] op_sel:[0,1] op_sel_hi:[1,1]
    v_pk_add_f32 v[32:33], v[32:33], s[40:41] op_sel_hi:[1,0] neg_lo:[0,1] neg_hi:[0,1]
    v_pk_add_f32 v[34:35], v[34:35], s[40:41] op_sel_hi:[1,0] neg_lo:[0,1] neg_hi:[0,1]
    v_pk_add_f32 v[36:37], v[36:37], s[40:41] op_sel_hi:[1,0] neg_lo:[0,1] neg_hi:[0,1]
    v_pk_add_f32 v[38:39], v[38:39], s[40:41] op_sel_hi:[1,0] neg_lo:[0,1] neg_hi:[0,1]
    v_pk_mul_f32 v[32:33], v[32:33], s[40:41] op_sel:[0,1] op_sel_hi:[1,1]
    v_pk_mul_f32 v[34:35], v[34:35], s[40:41] op_sel:[0,1] op_sel_hi:[1,1]
    v_pk_mul_f32 v[36:37], v[36:37], s[40:41] op_sel:[0,1] op_sel_hi:[1,1]
    v_pk_mul_f32 v[38:39], v[38:39], s[40:41] op_sel:[0,1] op_sel_hi:[1,1]
    v_pk_add_f32 v[40:41], v[40:41], s[42:43] op_sel_hi:[1,0] neg_lo:[0,1] neg_hi:[0,1]
    v_pk_add_f32 v[42:43], v[42:43], s[42:43] op_sel_hi:[1,0] neg_lo:[0,1] neg_hi:[0,1]
    v_pk_add_f32 v[44:45], v[44:45], s[42:43] op_sel_hi:[1,0] neg_lo:[0,1] neg_hi:[0,1]
    v_pk_add_f32 v[46:47], v[46:47], s[42:43] op_sel_hi:[1,0] neg_lo:[0,1] neg_hi:[0,1]
    v_pk_mul_f32 v[40:41], v[40:41], s[42:43] op_sel:[0,1] op_sel_hi:[1,1]
    v_pk_mul_f32 v[42:43], v[42:43], s[42:43] op_sel:[0,1] op_sel_hi:[1,1]
    v_pk_mul_f32 v[44:45], v[44:45], s[42:43] op_sel:[0,1] op_sel_hi:[1,1]
    v_pk_mul_f32 v[46:47], v[46:47], s[42:43] op_sel:[0,1] op_sel_hi:[1,1]
    v_pk_add_f32 v[48:49], v[48:49], s[44:45] op_sel_hi:[1,0] neg_lo:[0,1] neg_hi:[0,1]
    v_pk_add_f32 v[50:51], v[50:51], s[44:45] op_sel_hi:[1,0] neg_lo:[0,1] neg_hi:[0,1]
    v_pk_add_f32 v[52:53], v[52:53], s[44:45] op_sel_hi:[1,0] neg_lo:[0,1] neg_hi:[0,1]
    v_pk_add_f32 v[54:55], v[54:55], s[44:45] op_sel_hi:[1,0] neg_lo:[0,1] neg_hi:[0,1]
    v_pk_mul_f32 v[48:49], v[48:49], s[44:45] op_sel:[0,1] op_sel_hi:[1,1]
    v_pk_mul_f32 v[50:51], v[50:51], s[44:45] op_sel:[0,1] op_sel_hi:[1,1]
    v_pk_mul_f32 v[52:53], v[52:53], s[44:45] op_sel:[0,1] op_sel_hi:[1,1]
    v_pk_mul_f32 v[54:55], v[54:55], s[44:45] op_sel:[0,1] op_sel_hi:[1,1]
    v_pk_add_f32 v[56:57], v[56:57], s[46:47] op_sel_hi:[1,0] neg_lo:[0,1] neg_hi:[0,1]
    v_pk_add_f32 v[58:59], v[58:59], s[46:47] op_sel_hi:[1,0] neg_lo:[0,1] neg_hi:[0,1]
    v_pk_add_f32 v[60:61], v[60:61], s[46:47] op_sel_hi:[1,0] neg_lo:[0,1] neg_hi:[0,1]
    v_pk_add_f32 v[62:63], v[62:63], s[46:47] op_sel_hi:[1,0] neg_lo:[0,1] neg_hi:[0,1]
    v_pk_mul_f32 v[56:57], v[56:57], s[46:47] op_sel:[0,1] op_sel_hi:[1,1]
    v_pk_mul_f32 v[58:59], v[58:59], s[46:47] op_sel:[0,1] op_sel_hi:[1,1]
    v_pk_mul_f32 v[60:61], v[60:61], s[46:47] op_sel:[0,1] op_sel_hi:[1,1]
    v_pk_mul_f32 v[62:63], v[62:63], s[46:47] op_sel:[0,1] op_sel_hi:[1,1]
    v_pk_add_f32 v[64:65], v[64:65], s[48:49] op_sel_hi:[1,0] neg_lo:[0,1] neg_hi:[0,1]
    v_pk_add_f32 v[66:67], v[66:67], s[48:49] op_sel_hi:[1,0] neg_lo:[0,1] neg_hi:[0,1]
    v_pk_add_f32 v[68:69], v[68:69], s[48:49] op_sel_hi:[1,0] neg_lo:[0,1] neg_hi:[0,1]
    v_pk_add_f32 v[70:71], v[70:71], s[48:49] op_sel_hi:[1,0] neg_lo:[0,1] neg_hi:[0,1]
    v_pk_mul_f32 v[64:65], v[64:65], s[48:49] op_sel:[0,1] op_sel_hi:[1,1]
    v_pk_mul_f32 v[66:67], v[66:67], s[48:49] op_sel:[0,1] op_sel_hi:[1,1]
    v_pk_mul_f32 v[68:69], v[68:69], s[48:49] op_sel:[0,1] op_sel_hi:[1,1]
    v_pk_mul_f32 v[70:71], v[70:71], s[48:49] op_sel:[0,1] op_sel_hi:[1,1]
    v_pk_add_f32 v[72:73], v[72:73], s[50:51] op_sel_hi:[1,0] neg_lo:[0,1] neg_hi:[0,1]
    v_pk_add_f32 v[74:75], v[74:75], s[50:51] op_sel_hi:[1,0] neg_lo:[0,1] neg_hi:[0,1]
    v_pk_add_f32 v[76:77], v[76:77], s[50:51] op_sel_hi:[1,0] neg_lo:[0,1] neg_hi:[0,1]
    v_pk_add_f32 v[78:79], v[78:79], s[50:51] op_sel_hi:[1,0] neg_lo:[0,1] neg_hi:[0,1]
    v_pk_mul_f32 v[72:73], v[72:73], s[50:51] op_sel:[0,1] op_sel_hi:[1,1]
    v_pk_mul_f32 v[74:75], v[74:75], s[50:51] op_sel:[0,1] op_sel_hi:[1,1]
    v_pk_mul_f32 v[76:77], v[76:77], s[50:51] op_sel:[0,1] op_sel_hi:[1,1]
    v_pk_mul_f32 v[78:79], v[78:79], s[50:51] op_sel:[0,1] op_sel_hi:[1,1]
    v_cvt_pk_bf16_f32 v80, v16, v24
    v_cvt_pk_bf16_f32 v81, v32, v40
    v_cvt_pk_bf16_f32 v82, v48, v56
    v_cvt_pk_bf16_f32 v83, v64, v72
    ds_write_b128 v3, v[80:83] offset:0
    v_cvt_pk_bf16_f32 v84, v17, v25
    v_cvt_pk_bf16_f32 v85, v33, v41
    v_cvt_pk_bf16_f32 v86, v49, v57
    v_cvt_pk_bf16_f32 v87, v65, v73
    ds_write_b128 v3, v[84:87] offset:128
    v_cvt_pk_bf16_f32 v88, v18, v26
    v_cvt_pk_bf16_f32 v89, v34, v42
    v_cvt_pk_bf16_f32 v90, v50, v58
    v_cvt_pk_bf16_f32 v91, v66, v74
    ds_write_b128 v3, v[88:91] offset:256
    v_cvt_pk_bf16_f32 v92, v19, v27
    v_cvt_pk_bf16_f32 v93, v35, v43
    v_cvt_pk_bf16_f32 v94, v51, v59
    v_cvt_pk_bf16_f32 v95, v67, v75
    ds_write_b128 v3, v[92:95] offset:384
    v_cvt_pk_bf16_f32 v96, v20, v28
    v_cvt_pk_bf16_f32 v97, v36, v44
    v_cvt_pk_bf16_f32 v98, v52, v60
    v_cvt_pk_bf16_f32 v99, v68, v76
    ds_write_b128 v3, v[96:99] offset:512
    v_cvt_pk_bf16_f32 v100, v21, v29
    v_cvt_pk_bf16_f32 v101, v37, v45
    v_cvt_pk_bf16_f32 v102, v53, v61
    v_cvt_pk_bf16_f32 v103, v69, v77
    ds_write_b128 v3, v[100:103] offset:640
    v_cvt_pk_bf16_f32 v104, v22, v30
    v_cvt_pk_bf16_f32 v105, v38, v46
    v_cvt_pk_bf16_f32 v106, v54, v62
    v_cvt_pk_bf16_f32 v107, v70, v78
    ds_write_b128 v3, v[104:107] offset:768
    v_cvt_pk_bf16_f32 v108, v23, v31
    v_cvt_pk_bf16_f32 v109, v39, v47
    v_cvt_pk_bf16_f32 v110, v55, v63
    v_cvt_pk_bf16_f32 v111, v71, v79
    ds_write_b128 v3, v[108:111] offset:896
    v_lshlrev_b32 v3, 4, v1
    v_add_u32 v4, s35, v3
    v_xor_b32 v144, 0, v3
    v_xor_b32 v145, 16, v3
    v_xor_b32 v146, 32, v3
    v_xor_b32 v147, 48, v3
    v_xor_b32 v148, 64, v3
    v_xor_b32 v149, 80, v3
    v_xor_b32 v150, 96, v3
    v_xor_b32 v151, 112, v3
    s_mul_i32 s55, s33, 65792
    s_add_u32 s55, s55, s35
    s_add_u32 s56, s55, 4096
    s_waitcnt lgkmcnt(0)
    s_barrier
    ds_read_b128 v[160:163], v4 offset:49152
    ds_read_b128 v[164:167], v4 offset:50176
    ds_read_b128 v[168:171], v4 offset:51200
    ds_read_b128 v[172:175], v4 offset:52224
    ds_read_b128 v[176:179], v4 offset:53248
    ds_read_b128 v[180:183], v4 offset:54272
    ds_read_b128 v[184:187], v4 offset:55296
    ds_read_b128 v[188:191], v4 offset:56320
    s_waitcnt lgkmcnt(7)
    buffer_store_dwordx4 v[160:163], v144, s[28:31], s55 offen offset:0 sc1
    s_waitcnt lgkmcnt(6)
    buffer_store_dwordx4 v[164:167], v145, s[28:31], s55 offen offset:1024 sc1
    s_waitcnt lgkmcnt(5)
    buffer_store_dwordx4 v[168:171], v146, s[28:31], s55 offen offset:2048 sc1
    s_waitcnt lgkmcnt(4)
    buffer_store_dwordx4 v[172:175], v147, s[28:31], s55 offen offset:3072 sc1
    s_waitcnt lgkmcnt(3)
    buffer_store_dwordx4 v[176:179], v148, s[28:31], s56 offen offset:0 sc1
    s_waitcnt lgkmcnt(2)
    buffer_store_dwordx4 v[180:183], v149, s[28:31], s56 offen offset:1024 sc1
    s_waitcnt lgkmcnt(1)
    buffer_store_dwordx4 v[184:187], v150, s[28:31], s56 offen offset:2048 sc1
    s_waitcnt lgkmcnt(0)
    buffer_store_dwordx4 v[188:191], v151, s[28:31], s56 offen offset:3072 sc1
    s_cmp_lg_u32 s32, 4
    s_cbranch_scc1 W0_21
    s_waitcnt vmcnt(10)
    s_mov_b32 s62, 0
NP_22:
    v_readfirstlane_b32 s90, v9
    s_add_u32 s62, s62, 1
    s_nop 2
    s_cmp_lg_u32 s90, 0
    s_cbranch_scc1 NK_23
    s_cmp_ge_u32 s62, 0x4000
    s_cbranch_scc1 NK_23
    s_sleep 8
    buffer_load_dword v9, off, s[24:27], 0 sc1
    s_waitcnt vmcnt(0)
    s_branch NP_22
NK_23:
W0_21:
    s_cmp_lg_u32 s32, 4
    s_cbranch_scc1 W0_24
    v_mov_b32 v13, 163328
    v_mov_b32 v14, s90
    ds_write_b32 v13, v14
W0_24:
    s_cmp_lt_u32 s32, 4
    s_cbranch_scc1 AXK_25
    s_getpc_b64 s[92:93]
PC_26:
    s_add_u32 s92, s92, L_TAB-PC_26
    s_addc_u32 s93, s93, 0
    v_and_b32 v13, 255, v0
    v_lshlrev_b32 v13, 4, v13
    global_load_dwordx4 v[200:203], v13, s[92:93]
    v_add_u32 v13, 4096, v13
    global_load_dwordx4 v[204:207], v13, s[92:93]
    v_add_u32 v13, 4096, v13
    global_load_dwordx4 v[208:211], v13, s[92:93]
    v_add_u32 v13, 4096, v13
    global_load_dwordx4 v[212:215], v13, s[92:93]
    v_add_u32 v13, 4096, v13
    global_load_dwordx4 v[216:219], v13, s[92:93]
    s_bfe_u32 s55, s32, 0x10001
    s_mul_i32 s55, s55, 3072
    s_add_u32 s55, s55, 160004
    v_mov_b32 v222, s55
    ds_read_b128 v[16:19], v198 offset:0
    ds_read_b128 v[48:51], v235 offset:4352
    ds_read_b128 v[80:83], v235 offset:8704
    ds_read_b128 v[20:23], v198 offset:64
    ds_read_b128 v[52:55], v235 offset:4416
    ds_read_b128 v[84:87], v235 offset:8768
    ds_read_b128 v[24:27], v198 offset:128
    ds_read_b128 v[56:59], v235 offset:4480
    ds_read_b128 v[88:91], v235 offset:8832
    ds_read_b128 v[28:31], v198 offset:192
    ds_read_b128 v[60:63], v235 offset:4544
    ds_read_b128 v[92:95], v235 offset:8896
    ds_read_b128 v[32:35], v199 offset:0
    ds_read_b128 v[64:67], v236 offset:4352
    ds_read_b128 v[96:99], v236 offset:8704
    ds_read_b128 v[36:39], v199 offset:64
    ds_read_b128 v[68:71], v236 offset:4416
    ds_read_b128 v[100:103], v236 offset:8768
    ds_read_b128 v[40:43], v199 offset:128
    ds_read_b128 v[72:75], v236 offset:4480
    ds_read_b128 v[104:107], v236 offset:8832
    ds_read_b128 v[44:47], v199 offset:192
    ds_read_b128 v[76:79], v236 offset:4544
    ds_read_b128 v[108:111], v236 offset:8896
    v_and_b32 v13, 15, v1
    v_lshrrev_b32 v14, 4, v1
    v_lshl_add_u32 v192, v14, 3, v13
    s_bfe_u32 s55, s32, 0x10001
    s_mul_i32 s56, s55, 16640
    s_add_u32 s56, s56, 114688
    s_and_b32 s53, s32, 1
    s_lshl_b32 s54, s53, 5
    s_sub_u32 s54, 71, s54
    v_sub_u32 v192, s54, v192
    v_and_b32 v193, 3, v192
    v_sub_u32 v192, v192, v193
    v_lshlrev_b32 v192, 1, v192
    v_mul_u32_u24 v193, 4160, v193
    v_add3_u32 v232, v192, v193, s56
    v_lshlrev_b32 v192, 5, v13
    v_lshlrev_b32 v193, 4, v14
    v_sub_u32 v192, v192, v193
    s_mul_i32 s54, s55, 4608
    s_lshl_b32 s53, s53, 6
    s_sub_u32 s54, s54, s53
    s_add_u32 s54, s54, 148112
    v_add_u32 v233, s54, v192
    v_lshl_add_u32 v13, v14, 2, v13
    v_and_b32 v13, 15, v13
    v_lshl_add_u32 v13, v14, 4, v13
    s_lshl_b32 s53, s52, 3
    s_add_u32 s53, s53, 65536
    v_lshl_add_u32 v234, v13, 4, s53
    s_waitcnt lgkmcnt(0)
    v_mfma_f32_16x16x32_bf16 v[224:227], v[48:51], v[16:19], 0
    v_mfma_f32_16x16x32_bf16 v[228:231], v[80:83], v[16:19], 0
    v_mfma_f32_16x16x32_bf16 v[224:227], v[52:55], v[20:23], v[224:227]
    v_mfma_f32_16x16x32_bf16 v[228:231], v[84:87], v[20:23], v[228:231]
    v_mfma_f32_16x16x32_bf16 v[224:227], v[56:59], v[24:27], v[224:227]
    v_mfma_f32_16x16x32_bf16 v[228:231], v[88:91], v[24:27], v[228:231]
    v_mfma_f32_16x16x32_bf16 v[224:227], v[60:63], v[28:31], v[224:227]
    v_mfma_f32_16x16x32_bf16 v[228:231], v[92:95], v[28:31], v[228:231]
    v_mfma_f32_16x16x32_bf16 v[224:227], v[64:67], v[32:35], v[224:227]
    v_mfma_f32_16x16x32_bf16 v[228:231], v[96:99], v[32:35], v[228:231]
    v_mfma_f32_16x16x32_bf16 v[224:227], v[68:71], v[36:39], v[224:227]
    v_mfma_f32_16x16x32_bf16 v[228:231], v[100:103], v[36:39], v[228:231]
    v_mfma_f32_16x16x32_bf16 v[224:227], v[72:75], v[40:43], v[224:227]
    v_mfma_f32_16x16x32_bf16 v[228:231], v[104:107], v[40:43], v[228:231]
    v_mfma_f32_16x16x32_bf16 v[224:227], v[76:79], v[44:47], v[224:227]
    v_mfma_f32_16x16x32_bf16 v[228:231], v[108:111], v[44:47], v[228:231]
AXK_25:
    s_waitcnt vmcnt(0)
    s_barrier
    s_cmp_lg_u32 s32, 4
    s_cbranch_scc1 W0_27
    s_mov_b32 s62, 3407872
    s_lshl_b32 s60, s2, 7
    s_add_u32 s62, s62, s60
    v_mov_b32 v13, s90
    s_mov_b64 exec, 1
    buffer_store_dword v13, off, s[28:31], s62 sc1
    s_mov_b64 exec, -1
W0_27:
    s_cmp_ge_u32 s32, 4
    s_cbranch_scc1 L_AXH
    s_lshr_b32 s53, s2, 3
    s_lshl_b32 s53, s53, 1
    s_and_b32 s54, s32, 1
    s_add_u32 s53, s53, s54
    s_mul_i32 s53, s53, 224
    s_lshr_b32 s54, s32, 1
    s_add_u32 s53, s53, s54
    s_lshl_b32 s35, s53, 10
    s_and_b32 s34, s2, 7
    v_lshlrev_b32 v5, 4, v1
    s_sub_u32 s54, s34, 7
    s_cmp_ge_u32 s34, 7
    s_cselect_b32 s34, s54, s34
    s_lshl_b32 s53, s34, 15
    s_add_u32 s53, s53, s35
    buffer_load_dwordx4 v[16:19], v5, s[16:19], s53 offen offset:0
    buffer_load_dwordx4 v[20:23], v5, s[16:19], s53 offen offset:2048
    s_add_u32 s53, s53, 4096
    buffer_load_dwordx4 v[24:27], v5, s[16:19], s53 offen offset:0
    buffer_load_dwordx4 v[28:31], v5, s[16:19], s53 offen offset:2048
    s_add_u32 s53, s53, 4096
    buffer_load_dwordx4 v[32:35], v5, s[16:19], s53 offen offset:0
    buffer_load_dwordx4 v[36:39], v5, s[16:19], s53 offen offset:2048
    s_add_u32 s53, s53, 4096
    buffer_load_dwordx4 v[40:43], v5, s[16:19], s53 offen offset:0
    buffer_load_dwordx4 v[44:47], v5, s[16:19], s53 offen offset:2048
    s_add_u32 s53, s53, 4096
    buffer_load_dwordx4 v[48:51], v5, s[16:19], s53 offen offset:0
    buffer_load_dwordx4 v[52:55], v5, s[16:19], s53 offen offset:2048
    s_add_u32 s53, s53, 4096
    buffer_load_dwordx4 v[56:59], v5, s[16:19], s53 offen offset:0
    buffer_load_dwordx4 v[60:63], v5, s[16:19], s53 offen offset:2048
    s_add_u32 s53, s53, 4096
    buffer_load_dwordx4 v[64:67], v5, s[16:19], s53 offen offset:0
    buffer_load_dwordx4 v[68:71], v5, s[16:19], s53 offen offset:2048
    s_add_u32 s53, s53, 4096
    buffer_load_dwordx4 v[72:75], v5, s[16:19], s53 offen offset:0
    buffer_load_dwordx4 v[76:79], v5, s[16:19], s53 offen offset:2048
    s_add_u32 s53, s53, 4096
    s_add_u32 s34, s34, 1
    s_barrier
    s_barrier
    s_barrier
    s_sub_u32 s54, s34, 7
    s_cmp_ge_u32 s34, 7
    s_cselect_b32 s34, s54, s34
    s_lshl_b32 s53, s34, 15
    s_add_u32 s53, s53, s35
    buffer_load_dwordx4 v[16:19], v5, s[16:19], s53 offen offset:0
    buffer_load_dwordx4 v[20:23], v5, s[16:19], s53 offen offset:2048
    s_add_u32 s53, s53, 4096
    buffer_load_dwordx4 v[24:27], v5, s[16:19], s53 offen offset:0
    buffer_load_dwordx4 v[28:31], v5, s[16:19], s53 offen offset:2048
    s_add_u32 s53, s53, 4096
    buffer_load_dwordx4 v[32:35], v5, s[16:19], s53 offen offset:0
    buffer_load_dwordx4 v[36:39], v5, s[16:19], s53 offen offset:2048
    s_add_u32 s53, s53, 4096
    buffer_load_dwordx4 v[40:43], v5, s[16:19], s53 offen offset:0
    buffer_load_dwordx4 v[44:47], v5, s[16:19], s53 offen offset:2048
    s_add_u32 s53, s53, 4096
    buffer_load_dwordx4 v[48:51], v5, s[16:19], s53 offen offset:0
    buffer_load_dwordx4 v[52:55], v5, s[16:19], s53 offen offset:2048
    s_add_u32 s53, s53, 4096
    buffer_load_dwordx4 v[56:59], v5, s[16:19], s53 offen offset:0
    buffer_load_dwordx4 v[60:63], v5, s[16:19], s53 offen offset:2048
    s_add_u32 s53, s53, 4096
    buffer_load_dwordx4 v[64:67], v5, s[16:19], s53 offen offset:0
    buffer_load_dwordx4 v[68:71], v5, s[16:19], s53 offen offset:2048
    s_add_u32 s53, s53, 4096
    buffer_load_dwordx4 v[72:75], v5, s[16:19], s53 offen offset:0
    buffer_load_dwordx4 v[76:79], v5, s[16:19], s53 offen offset:2048
    s_add_u32 s53, s53, 4096
    s_add_u32 s34, s34, 1
    s_waitcnt vmcnt(0)
    s_branch L_J
L_AXH:
    s_waitcnt vmcnt(0)
    s_nop 7
    v_mov_b32 v13, 0
    ds_write_b16 v222, v13
    v_cvt_pk_bf16_f32 v224, v224, v224
    v_cvt_pk_bf16_f32 v225, v225, v225
    v_cvt_pk_bf16_f32 v226, v226, v226
    v_cvt_pk_bf16_f32 v227, v227, v227
    v_cvt_pk_bf16_f32 v228, v228, v228
    v_cvt_pk_bf16_f32 v229, v229, v229
    v_cvt_pk_bf16_f32 v230, v230, v230
    v_cvt_pk_bf16_f32 v231, v231, v231
    ds_write_b16 v200, v224
    ds_write_b16 v201, v225
    ds_write_b16 v202, v226
    ds_write_b16 v203, v227
    ds_write_b16 v204, v228
    ds_write_b16 v205, v229
    ds_write_b16 v206, v230
    ds_write_b16 v207, v231
    s_waitcnt lgkmcnt(0)
    s_barrier
    s_cmp_lg_u32 s32, 4
    s_cbranch_scc1 W0_28
    s_mov_b32 s91, 3407872
    v_lshlrev_b32 v8, 7, v1
    s_mov_b64 exec, 0xffffffff
    buffer_load_dword v8, v8, s[28:31], s91 offen sc1
    s_mov_b64 exec, -1
W0_28:
    ds_read_u16 v16, v208 offset:0
    ds_read_u16 v17, v209 offset:0
    ds_read_u16 v18, v210 offset:0
    ds_read_u16 v19, v211 offset:0
    ds_read_u16 v20, v212 offset:0
    ds_read_u16 v21, v213 offset:0
    ds_read_u16 v22, v214 offset:0
    ds_read_u16 v23, v215 offset:0
    ds_read_u16 v24, v216 offset:0
    ds_read_u16 v25, v217 offset:0
    ds_read_u16 v26, v218 offset:0
    ds_read_u16 v28, v208 offset:3072
    ds_read_u16 v29, v209 offset:3072
    ds_read_u16 v30, v210 offset:3072
    ds_read_u16 v31, v211 offset:3072
    ds_read_u16 v32, v212 offset:3072
    ds_read_u16 v33, v213 offset:3072
    ds_read_u16 v34, v214 offset:3072
    ds_read_u16 v35, v215 offset:3072
    ds_read_u16 v36, v216 offset:3072
    ds_read_u16 v37, v217 offset:3072
    ds_read_u16 v38, v218 offset:3072
    s_cmp_lt_u32 s32, 6
    s_cbranch_scc1 Z_30
    v_mov_b32 v192, 0
    v_mov_b32 v193, 0
    v_mov_b32 v194, 0
    v_mov_b32 v195, 0
    v_lshrrev_b32 v13, 5, v1
    v_lshlrev_b32 v13, 12, v13
    v_lshl_add_u32 v13, v1, 4, v13
    v_add_u32 v13, 147968, v13
    s_cmp_eq_u32 s32, 6
    s_cbranch_scc1 Z_29
    v_bfe_u32 v13, v1, 1, 3
    v_mul_u32_u24 v13, 4160, v13
    v_and_b32 v14, 1, v1
    v_lshl_add_u32 v13, v14, 4, v13
    v_add_u32 v13, 118784, v13
Z_29:
    ds_write_b128 v13, v[192:195]
Z_30:
    s_waitcnt lgkmcnt(0)
    v_lshl_or_b32 v40, v17, 16, v16
    v_lshl_or_b32 v41, v19, 16, v18
    v_lshl_or_b32 v42, v21, 16, v20
    v_lshl_or_b32 v43, v23, 16, v22
    ds_write_b128 v219, v[40:43] offset:0
    v_lshl_or_b32 v44, v18, 16, v17
    v_lshl_or_b32 v45, v20, 16, v19
    v_lshl_or_b32 v46, v22, 16, v21
    v_lshl_or_b32 v47, v24, 16, v23
    ds_write_b128 v219, v[44:47] offset:4160
    v_lshl_or_b32 v48, v19, 16, v18
    v_lshl_or_b32 v49, v21, 16, v20
    v_lshl_or_b32 v50, v23, 16, v22
    v_lshl_or_b32 v51, v25, 16, v24
    ds_write_b128 v219, v[48:51] offset:8320
    v_lshl_or_b32 v52, v20, 16, v19
    v_lshl_or_b32 v53, v22, 16, v21
    v_lshl_or_b32 v54, v24, 16, v23
    v_lshl_or_b32 v55, v26, 16, v25
    ds_write_b128 v219, v[52:55] offset:12480
    v_lshl_or_b32 v56, v29, 16, v28
    v_lshl_or_b32 v57, v31, 16, v30
    v_lshl_or_b32 v58, v33, 16, v32
    v_lshl_or_b32 v59, v35, 16, v34
    ds_write_b128 v219, v[56:59] offset:16640
    v_lshl_or_b32 v60, v30, 16, v29
    v_lshl_or_b32 v61, v32, 16, v31
    v_lshl_or_b32 v62, v34, 16, v33
    v_lshl_or_b32 v63, v36, 16, v35
    ds_write_b128 v219, v[60:63] offset:20800
    v_lshl_or_b32 v64, v31, 16, v30
    v_lshl_or_b32 v65, v33, 16, v32
    v_lshl_or_b32 v66, v35, 16, v34
    v_lshl_or_b32 v67, v37, 16, v36
    ds_write_b128 v219, v[64:67] offset:24960
    v_lshl_or_b32 v68, v32, 16, v31
    v_lshl_or_b32 v69, v34, 16, v33
    v_lshl_or_b32 v70, v36, 16, v35
    v_lshl_or_b32 v71, v38, 16, v37
    ds_write_b128 v219, v[68:71] offset:29120
    s_cmp_lg_u32 s32, 4
    s_cbranch_scc1 W0_32
    s_waitcnt vmcnt(0)
    s_mov_b32 s62, 0
POLL_31:
    v_cmp_ne_u32 vcc, s90, v8
    s_add_u32 s62, s62, 1
    s_and_b32 s60, vcc_lo, 0xffffffff
    s_cbranch_scc0 W0_32
    s_cmp_ge_u32 s62, 0x4000
    s_cbranch_scc1 W0_32
    s_sleep 2
    v_lshlrev_b32 v8, 7, v1
    s_mov_b64 exec, 0xffffffff
    buffer_load_dword v8, v8, s[28:31], s91 offen sc1
    s_mov_b64 exec, -1
    s_waitcnt vmcnt(0)
    s_branch POLL_31
W0_32:
    s_barrier
    v_bfe_u32 v13, v0, 4, 4
    v_mul_u32_u24 v13, 65792, v13
    v_and_b32 v14, 15, v0
    v_lshl_add_u32 v13, v14, 4, v13
    s_lshl_b32 s54, s2, 8
    s_add_u32 s55, s54, 1052672
    buffer_load_dwordx4 v[72:75], v13, s[28:31], s54 offen sc1
    buffer_load_dwordx4 v[76:79], v13, s[28:31], s55 offen sc1
    v_bfe_u32 v13, v0, 4, 4
    v_lshlrev_b32 v13, 7, v13
    v_and_b32 v14, 7, v0
    v_lshl_add_u32 v13, v14, 4, v13
    v_bfe_u32 v14, v0, 3, 1
    v_mul_u32_u24 v14, 4608, v14
    v_add_u32 v13, v13, v14
    v_add_u32 v13, 148480, v13
    s_waitcnt vmcnt(0)
    ds_write_b128 v13, v[72:75]
    ds_write_b128 v13, v[76:79] offset:2048
    s_waitcnt lgkmcnt(0)
    s_barrier
    s_branch L_ACONV
L_J:
    s_setprio 0
    s_waitcnt vmcnt(0) lgkmcnt(0)
    s_barrier
    ds_read_b128 v[80:83], v249 offset:0
    ds_read_b128 v[84:87], v249 offset:8192
    ds_read_b128 v[88:91], v249 offset:16384
    ds_read_b128 v[92:95], v249 offset:24576
    ds_read_b64 v[96:97], v250
    ds_read_b64 v[98:99], v250 offset:4608
    v_mov_b32 v3, 163328
    ds_read_b32 v3, v3
    ds_read_b64_tr_b16 v[128:129], v245 offset:0
    ds_read_b64_tr_b16 v[130:131], v245 offset:2048
    ds_read_b64_tr_b16 v[132:133], v246 offset:0
    ds_read_b64_tr_b16 v[134:135], v246 offset:2048
    ds_read_b64_tr_b16 v[136:137], v247 offset:0
    ds_read_b64_tr_b16 v[138:139], v247 offset:2048
    ds_read_b64_tr_b16 v[140:141], v248 offset:0
    ds_read_b64_tr_b16 v[142:143], v248 offset:2048
    ds_read_b64_tr_b16 v[144:145], v245 offset:32768
    ds_read_b64_tr_b16 v[146:147], v245 offset:34816
    ds_read_b64_tr_b16 v[148:149], v246 offset:32768
    ds_read_b64_tr_b16 v[150:151], v246 offset:34816
    ds_read_b64_tr_b16 v[152:153], v247 offset:32768
    ds_read_b64_tr_b16 v[154:155], v247 offset:34816
    ds_read_b64_tr_b16 v[156:157], v248 offset:32768
    ds_read_b64_tr_b16 v[158:159], v248 offset:34816
    s_cmp_lt_u32 s2, 32
    s_cbranch_scc1 PH_33
    s_cmp_lg_u32 s32, 4
    s_cbranch_scc1 W0_34
    s_mul_i32 s62, s33, 4224
    s_add_u32 s62, s62, 3412096
    s_lshl_b32 s60, s34, 7
    s_add_u32 s62, s62, s60
    v_mov_b32 v14, s90
    s_mov_b64 exec, 1
    buffer_store_dword v14, off, s[28:31], s62 sc1
    s_mov_b64 exec, -1
W0_34:
PH_33:
    s_lshl_b32 s94, s66, 5
    s_add_u32 s94, s94, s71
    s_add_u32 m0, s72, 114688
    s_add_u32 s94, s94, 0
    buffer_load_dwordx4 v244, s[16:19], s94 offen lds
    s_add_u32 m0, s72, 115712
    s_add_u32 s94, s94, 8192
    buffer_load_dwordx4 v244, s[16:19], s94 offen lds
    s_add_u32 m0, s72, 116736
    s_add_u32 s94, s94, 8192
    buffer_load_dwordx4 v244, s[16:19], s94 offen lds
    s_add_u32 m0, s72, 117760
    s_add_u32 s94, s94, 8192
    buffer_load_dwordx4 v244, s[16:19], s94 offen lds
    v_add_u32 v4, 0x10000, v245
    v_add_u32 v5, 0x10000, v246
    v_add_u32 v6, 0x10000, v247
    v_add_u32 v7, 0x10000, v248
    s_lshl_b32 s53, s63, 16
    s_and_b32 s54, s63, 0xffff0000
    s_waitcnt lgkmcnt(15)
    v_readfirstlane_b32 s90, v3
    v_add_f32 v80, v80, v84
    v_add_f32 v81, v81, v85
    v_add_f32 v82, v82, v86
    v_add_f32 v83, v83, v87
    v_lshlrev_b32 v100, 16, v96
    v_and_b32 v101, 0xffff0000, v96
    v_lshlrev_b32 v102, 16, v97
    v_and_b32 v103, 0xffff0000, v97
    v_mul_f32 v100, s53, v100
    v_mul_f32 v101, s53, v101
    v_mul_f32 v102, s53, v102
    v_mul_f32 v103, s53, v103
    v_cvt_pk_bf16_f32 v84, v80, v100
    v_cvt_pk_bf16_f32 v85, v81, v101
    v_cvt_pk_bf16_f32 v86, v82, v102
    v_cvt_pk_bf16_f32 v87, v83, v103
    v_lshlrev_b32 v80, 16, v84
    v_and_b32 v84, 0xffff0000, v84
    v_lshlrev_b32 v81, 16, v85
    v_and_b32 v85, 0xffff0000, v85
    v_lshlrev_b32 v82, 16, v86
    v_and_b32 v86, 0xffff0000, v86
    v_lshlrev_b32 v83, 16, v87
    v_and_b32 v87, 0xffff0000, v87
    v_add_f32 v80, v80, v84
    v_add_f32 v81, v81, v85
    v_add_f32 v82, v82, v86
    v_add_f32 v83, v83, v87
    v_add_f32 v88, v88, v92
    v_add_f32 v89, v89, v93
    v_add_f32 v90, v90, v94
    v_add_f32 v91, v91, v95
    v_lshlrev_b32 v100, 16, v98
    v_and_b32 v101, 0xffff0000, v98
    v_lshlrev_b32 v102, 16, v99
    v_and_b32 v103, 0xffff0000, v99
    v_mul_f32 v100, s54, v100
    v_mul_f32 v101, s54, v101
    v_mul_f32 v102, s54, v102
    v_mul_f32 v103, s54, v103
    v_cvt_pk_bf16_f32 v92, v88, v100
    v_cvt_pk_bf16_f32 v93, v89, v101
    v_cvt_pk_bf16_f32 v94, v90, v102
    v_cvt_pk_bf16_f32 v95, v91, v103
    v_lshlrev_b32 v88, 16, v92
    v_and_b32 v92, 0xffff0000, v92
    v_lshlrev_b32 v89, 16, v93
    v_and_b32 v93, 0xffff0000, v93
    v_lshlrev_b32 v90, 16, v94
    v_and_b32 v94, 0xffff0000, v94
    v_lshlrev_b32 v91, 16, v95
    v_and_b32 v95, 0xffff0000, v95
    v_add_f32 v88, v88, v92
    v_add_f32 v89, v89, v93
    v_add_f32 v90, v90, v94
    v_add_f32 v91, v91, v95
    v_cvt_pk_bf16_f32 v104, v80, v88
    v_cvt_pk_bf16_f32 v105, v81, v89
    v_cvt_pk_bf16_f32 v106, v82, v90
    v_cvt_pk_bf16_f32 v107, v83, v91
    v_lshlrev_b32 v13, 4, v0
    s_mul_i32 s53, s2, 8320
    s_add_u32 s53, s53, 12582912
    buffer_store_dwordx4 v[104:107], v13, s[28:31], s53 offen sc1
    s_waitcnt lgkmcnt(0)
    s_lshl_b32 s94, s67, 5
    s_add_u32 s94, s94, s71
    s_add_u32 m0, s72, 0
    s_add_u32 s94, s94, 0
    buffer_load_dwordx4 v244, s[16:19], s94 offen lds
    s_add_u32 m0, s72, 1024
    s_add_u32 s94, s94, 8192
    buffer_load_dwordx4 v244, s[16:19], s94 offen lds
    s_add_u32 m0, s72, 2048
    s_add_u32 s94, s94, 8192
    buffer_load_dwordx4 v244, s[16:19], s94 offen lds
    s_add_u32 m0, s72, 3072
    s_add_u32 s94, s94, 8192
    buffer_load_dwordx4 v244, s[16:19], s94 offen lds
    s_lshl_b32 s94, s68, 5
    s_add_u32 s94, s94, s71
    s_add_u32 m0, s72, 32768
    s_add_u32 s94, s94, 0
    buffer_load_dwordx4 v244, s[16:19], s94 offen lds
    s_add_u32 m0, s72, 33792
    s_add_u32 s94, s94, 8192
    buffer_load_dwordx4 v244, s[16:19], s94 offen lds
    s_add_u32 m0, s72, 34816
    s_add_u32 s94, s94, 8192
    buffer_load_dwordx4 v244, s[16:19], s94 offen lds
    s_add_u32 m0, s72, 35840
    s_add_u32 s94, s94, 8192
    buffer_load_dwordx4 v244, s[16:19], s94 offen lds
    s_waitcnt vmcnt(9)
    ds_read_b64_tr_b16 v[160:161], v4 offset:49152
    ds_read_b64_tr_b16 v[162:163], v4 offset:51200
    ds_read_b64_tr_b16 v[164:165], v5 offset:49152
    ds_read_b64_tr_b16 v[166:167], v5 offset:51200
    ds_read_b64_tr_b16 v[168:169], v6 offset:49152
    ds_read_b64_tr_b16 v[170:171], v6 offset:51200
    ds_read_b64_tr_b16 v[172:173], v7 offset:49152
    ds_read_b64_tr_b16 v[174:175], v7 offset:51200
    s_lshr_b32 s53, s57, 1
    s_cmp_lg_u32 s32, 0
    s_cbranch_scc1 W0_35
    s_mul_i32 s91, s53, 4224
    s_add_u32 s91, s91, 3412096
    v_lshlrev_b32 v8, 7, v1
    s_mov_b64 exec, 0x3fff
    buffer_load_dword v8, v8, s[28:31], s91 offen sc1
    s_mov_b64 exec, -1
W0_35:
    v_lshlrev_b32 v11, 4, v1
    v_lshrrev_b32 v14, 3, v1
    v_lshlrev_b32 v14, 10, v14
    v_and_b32 v12, 7, v1
    v_lshl_add_u32 v12, v12, 4, v14
    v_and_b32 v13, 15, v1
    v_lshrrev_b32 v14, 4, v1
    v_lshrrev_b32 v9, 5, v1
    v_lshl_add_u32 v9, v9, 2, v13
    v_add_u32 v10, 8, v9
    v_and_b32 v9, 15, v9
    v_and_b32 v10, 15, v10
    v_lshl_add_u32 v9, v14, 4, v9
    v_lshl_add_u32 v10, v14, 4, v10
    v_lshl_add_u32 v9, v9, 4, s72
    v_lshl_add_u32 v10, v10, 4, s72
    s_waitcnt lgkmcnt(0)
    s_lshl_b32 s94, s69, 5
    s_add_u32 s94, s94, s71
    s_add_u32 m0, s72, 114688
    s_add_u32 s94, s94, 0
    buffer_load_dwordx4 v244, s[16:19], s94 offen lds
    s_add_u32 m0, s72, 115712
    s_add_u32 s94, s94, 8192
    buffer_load_dwordx4 v244, s[16:19], s94 offen lds
    s_add_u32 m0, s72, 116736
    s_add_u32 s94, s94, 8192
    buffer_load_dwordx4 v244, s[16:19], s94 offen lds
    s_add_u32 m0, s72, 117760
    s_add_u32 s94, s94, 8192
    buffer_load_dwordx4 v244, s[16:19], s94 offen lds
    s_waitcnt vmcnt(12)
    s_cmp_lg_u32 s32, 0
    s_cbranch_scc1 W0_37
    s_waitcnt vmcnt(4)
    s_mov_b32 s62, 0
POLL_36:
    v_cmp_ne_u32 vcc, s90, v8
    s_add_u32 s62, s62, 1
    s_and_b32 s60, vcc_lo, 0x3fff
    s_cbranch_scc0 W0_37
    s_cmp_ge_u32 s62, 0x4000
    s_cbranch_scc1 W0_37
    s_sleep 2
    v_lshlrev_b32 v8, 7, v1
    s_mov_b64 exec, 0x3fff
    buffer_load_dword v8, v8, s[28:31], s91 offen sc1
    s_mov_b64 exec, -1
    s_waitcnt vmcnt(0)
    s_branch POLL_36
W0_37:
    s_barrier
    s_lshl_b32 s94, s70, 5
    s_add_u32 s94, s94, s71
    s_add_u32 m0, s72, 65536
    s_add_u32 s94, s94, 0
    buffer_load_dwordx4 v244, s[16:19], s94 offen lds
    s_add_u32 m0, s72, 66560
    s_add_u32 s94, s94, 8192
    buffer_load_dwordx4 v244, s[16:19], s94 offen lds
    s_add_u32 m0, s72, 67584
    s_add_u32 s94, s94, 8192
    buffer_load_dwordx4 v244, s[16:19], s94 offen lds
    s_add_u32 m0, s72, 68608
    s_add_u32 s94, s94, 8192
    buffer_load_dwordx4 v244, s[16:19], s94 offen lds
    s_add_u32 s97, s73, s64
    buffer_load_dwordx4 v[16:19], v11, s[28:31], s97 offen sc1
    s_add_u32 s97, s73, s65
    buffer_load_dwordx4 v[20:23], v11, s[28:31], s97 offen sc1
    s_add_u32 s97, s73, s66
    buffer_load_dwordx4 v[24:27], v11, s[28:31], s97 offen sc1
    s_add_u32 s97, s73, s67
    buffer_load_dwordx4 v[28:31], v11, s[28:31], s97 offen sc1
    s_lshr_b32 s53, s2, 5
    s_cmp_lg_u32 s32, 0
    s_cbranch_scc1 W0_38
    s_mul_i32 s62, s53, 4224
    s_add_u32 s62, s62, 3479680
    s_and_b32 s60, s2, 31
    s_lshl_b32 s60, s60, 7
    s_add_u32 s62, s62, s60
    v_mov_b32 v13, s90
    s_mov_b64 exec, 1
    buffer_store_dword v13, off, s[28:31], s62 sc1
    s_mov_b64 exec, -1
W0_38:
    s_waitcnt vmcnt(16)
    ds_read_b64_tr_b16 v[176:177], v245 offset:0
    ds_read_b64_tr_b16 v[178:179], v245 offset:2048
    ds_read_b64_tr_b16 v[180:181], v246 offset:0
    ds_read_b64_tr_b16 v[182:183], v246 offset:2048
    ds_read_b64_tr_b16 v[184:185], v247 offset:0
    ds_read_b64_tr_b16 v[186:187], v247 offset:2048
    ds_read_b64_tr_b16 v[188:189], v248 offset:0
    ds_read_b64_tr_b16 v[190:191], v248 offset:2048
    s_waitcnt vmcnt(12)
    ds_read_b64_tr_b16 v[192:193], v245 offset:32768
    ds_read_b64_tr_b16 v[194:195], v245 offset:34816
    ds_read_b64_tr_b16 v[196:197], v246 offset:32768
    ds_read_b64_tr_b16 v[198:199], v246 offset:34816
    ds_read_b64_tr_b16 v[200:201], v247 offset:32768
    ds_read_b64_tr_b16 v[202:203], v247 offset:34816
    ds_read_b64_tr_b16 v[204:205], v248 offset:32768
    ds_read_b64_tr_b16 v[206:207], v248 offset:34816
    s_add_u32 s97, s73, s68
    buffer_load_dwordx4 v[32:35], v11, s[28:31], s97 offen sc1
    s_add_u32 s97, s73, s69
    buffer_load_dwordx4 v[36:39], v11, s[28:31], s97 offen sc1
    s_add_u32 s97, s73, s70
    buffer_load_dwordx4 v[40:43], v11, s[28:31], s97 offen sc1
    s_add_u32 s97, s74, s64
    buffer_load_dwordx4 v[44:47], v11, s[28:31], s97 offen sc1
    s_waitcnt vmcnt(12)
    ds_read_b64_tr_b16 v[208:209], v4 offset:49152
    ds_read_b64_tr_b16 v[210:211], v4 offset:51200
    ds_read_b64_tr_b16 v[212:213], v5 offset:49152
    ds_read_b64_tr_b16 v[214:215], v5 offset:51200
    ds_read_b64_tr_b16 v[216:217], v6 offset:49152
    ds_read_b64_tr_b16 v[218:219], v6 offset:51200
    ds_read_b64_tr_b16 v[220:221], v7 offset:49152
    ds_read_b64_tr_b16 v[222:223], v7 offset:51200
    s_waitcnt vmcnt(8)
    ds_read_b64_tr_b16 v[224:225], v4 offset:0
    ds_read_b64_tr_b16 v[226:227], v4 offset:2048
    ds_read_b64_tr_b16 v[228:229], v5 offset:0
    ds_read_b64_tr_b16 v[230:231], v5 offset:2048
    ds_read_b64_tr_b16 v[232:233], v6 offset:0
    ds_read_b64_tr_b16 v[234:235], v6 offset:2048
    ds_read_b64_tr_b16 v[236:237], v7 offset:0
    ds_read_b64_tr_b16 v[238:239], v7 offset:2048
    s_waitcnt lgkmcnt(0)
    s_waitcnt vmcnt(7)
    v_mfma_f32_16x16x32_bf16 v[240:243], v[128:131], v[16:19], 0
    v_mfma_f32_16x16x32_bf16 v[244:247], v[132:135], v[16:19], 0
    v_mfma_f32_16x16x32_bf16 v[248:251], v[136:139], v[16:19], 0
    v_mfma_f32_16x16x32_bf16 v[252:255], v[140:143], v[16:19], 0
    s_add_u32 s97, s74, s65
    buffer_load_dwordx4 v[48:51], v11, s[28:31], s97 offen sc1
    s_waitcnt vmcnt(7)
    v_mfma_f32_16x16x32_bf16 v[240:243], v[144:147], v[20:23], v[240:243]
    v_mfma_f32_16x16x32_bf16 v[244:247], v[148:151], v[20:23], v[244:247]
    v_mfma_f32_16x16x32_bf16 v[248:251], v[152:155], v[20:23], v[248:251]
    v_mfma_f32_16x16x32_bf16 v[252:255], v[156:159], v[20:23], v[252:255]
    s_add_u32 s97, s74, s66
    buffer_load_dwordx4 v[52:55], v11, s[28:31], s97 offen sc1
    s_waitcnt vmcnt(7)
    v_mfma_f32_16x16x32_bf16 v[240:243], v[160:163], v[24:27], v[240:243]
    v_mfma_f32_16x16x32_bf16 v[244:247], v[164:167], v[24:27], v[244:247]
    v_mfma_f32_16x16x32_bf16 v[248:251], v[168:171], v[24:27], v[248:251]
    v_mfma_f32_16x16x32_bf16 v[252:255], v[172:175], v[24:27], v[252:255]
    s_add_u32 s97, s74, s67
    buffer_load_dwordx4 v[56:59], v11, s[28:31], s97 offen sc1
    s_waitcnt vmcnt(7)
    v_mfma_f32_16x16x32_bf16 v[240:243], v[176:179], v[28:31], v[240:243]
    v_mfma_f32_16x16x32_bf16 v[244:247], v[180:183], v[28:31], v[244:247]
    v_mfma_f32_16x16x32_bf16 v[248:251], v[184:187], v[28:31], v[248:251]
    v_mfma_f32_16x16x32_bf16 v[252:255], v[188:191], v[28:31], v[252:255]
    s_add_u32 s97, s74, s68
    buffer_load_dwordx4 v[60:63], v11, s[28:31], s97 offen sc1
    s_waitcnt vmcnt(7)
    v_mfma_f32_16x16x32_bf16 v[240:243], v[192:195], v[32:35], v[240:243]
    v_mfma_f32_16x16x32_bf16 v[244:247], v[196:199], v[32:35], v[244:247]
    v_mfma_f32_16x16x32_bf16 v[248:251], v[200:203], v[32:35], v[248:251]
    v_mfma_f32_16x16x32_bf16 v[252:255], v[204:207], v[32:35], v[252:255]
    s_add_u32 s97, s74, s69
    buffer_load_dwordx4 v[64:67], v11, s[28:31], s97 offen sc1
    s_waitcnt vmcnt(7)
    v_mfma_f32_16x16x32_bf16 v[240:243], v[208:211], v[36:39], v[240:243]
    v_mfma_f32_16x16x32_bf16 v[244:247], v[212:215], v[36:39], v[244:247]
    v_mfma_f32_16x16x32_bf16 v[248:251], v[216:219], v[36:39], v[248:251]
    v_mfma_f32_16x16x32_bf16 v[252:255], v[220:223], v[36:39], v[252:255]
    s_add_u32 s97, s74, s70
    buffer_load_dwordx4 v[68:71], v11, s[28:31], s97 offen sc1
    s_waitcnt vmcnt(7)
    v_mfma_f32_16x16x32_bf16 v[240:243], v[224:227], v[40:43], v[240:243]
    v_mfma_f32_16x16x32_bf16 v[244:247], v[228:231], v[40:43], v[244:247]
    v_mfma_f32_16x16x32_bf16 v[248:251], v[232:235], v[40:43], v[248:251]
    v_mfma_f32_16x16x32_bf16 v[252:255], v[236:239], v[40:43], v[252:255]
    s_add_u32 s97, s75, s64
    buffer_load_dwordx4 v[72:75], v11, s[28:31], s97 offen sc1
    s_waitcnt vmcnt(7)
    v_mfma_f32_16x16x32_bf16 v[16:19], v[128:131], v[44:47], 0
    v_mfma_f32_16x16x32_bf16 v[20:23], v[132:135], v[44:47], 0
    v_mfma_f32_16x16x32_bf16 v[24:27], v[136:139], v[44:47], 0
    v_mfma_f32_16x16x32_bf16 v[28:31], v[140:143], v[44:47], 0
    s_add_u32 s97, s75, s65
    buffer_load_dwordx4 v[76:79], v11, s[28:31], s97 offen sc1
    s_waitcnt vmcnt(7)
    v_mfma_f32_16x16x32_bf16 v[16:19], v[144:147], v[48:51], v[16:19]
    v_mfma_f32_16x16x32_bf16 v[20:23], v[148:151], v[48:51], v[20:23]
    v_mfma_f32_16x16x32_bf16 v[24:27], v[152:155], v[48:51], v[24:27]
    v_mfma_f32_16x16x32_bf16 v[28:31], v[156:159], v[48:51], v[28:31]
    s_add_u32 s97, s75, s66
    buffer_load_dwordx4 v[80:83], v11, s[28:31], s97 offen sc1
    s_waitcnt vmcnt(7)
    v_mfma_f32_16x16x32_bf16 v[16:19], v[160:163], v[52:55], v[16:19]
    v_mfma_f32_16x16x32_bf16 v[20:23], v[164:167], v[52:55], v[20:23]
    v_mfma_f32_16x16x32_bf16 v[24:27], v[168:171], v[52:55], v[24:27]
    v_mfma_f32_16x16x32_bf16 v[28:31], v[172:175], v[52:55], v[28:31]
    s_add_u32 s97, s75, s67
    buffer_load_dwordx4 v[84:87], v11, s[28:31], s97 offen sc1
    ds_write_b128 v9, v[240:243] offset:0
    ds_write_b128 v10, v[244:247] offset:1024
    ds_write_b128 v9, v[248:251] offset:2048
    ds_write_b128 v10, v[252:255] offset:3072
    s_waitcnt vmcnt(7)
    v_mfma_f32_16x16x32_bf16 v[16:19], v[176:179], v[56:59], v[16:19]
    v_mfma_f32_16x16x32_bf16 v[20:23], v[180:183], v[56:59], v[20:23]
    v_mfma_f32_16x16x32_bf16 v[24:27], v[184:187], v[56:59], v[24:27]
    v_mfma_f32_16x16x32_bf16 v[28:31], v[188:191], v[56:59], v[28:31]
    s_add_u32 s97, s75, s68
    buffer_load_dwordx4 v[88:91], v11, s[28:31], s97 offen sc1
    s_waitcnt vmcnt(7)
    v_mfma_f32_16x16x32_bf16 v[16:19], v[192:195], v[60:63], v[16:19]
    v_mfma_f32_16x16x32_bf16 v[20:23], v[196:199], v[60:63], v[20:23]
    v_mfma_f32_16x16x32_bf16 v[24:27], v[200:203], v[60:63], v[24:27]
    v_mfma_f32_16x16x32_bf16 v[28:31], v[204:207], v[60:63], v[28:31]
    s_add_u32 s97, s75, s69
    buffer_load_dwordx4 v[92:95], v11, s[28:31], s97 offen sc1
    s_waitcnt vmcnt(7)
    v_mfma_f32_16x16x32_bf16 v[16:19], v[208:211], v[64:67], v[16:19]
    v_mfma_f32_16x16x32_bf16 v[20:23], v[212:215], v[64:67], v[20:23]
    v_mfma_f32_16x16x32_bf16 v[24:27], v[216:219], v[64:67], v[24:27]
    v_mfma_f32_16x16x32_bf16 v[28:31], v[220:223], v[64:67], v[28:31]
    s_cmp_lg_u32 s32, 0
    s_cbranch_scc1 W0_39
    s_mul_i32 s91, s58, 4224
    s_add_u32 s91, s91, 3479680
    v_lshlrev_b32 v8, 7, v1
    s_mov_b64 exec, 0xffffffff
    buffer_load_dword v8, v8, s[28:31], s91 offen sc1
    s_mov_b64 exec, -1
W0_39:
    buffer_load_dwordx4 v[32:35], v12, s[4:7], s77 offen
    s_add_u32 s97, s75, s70
    buffer_load_dwordx4 v[96:99], v11, s[28:31], s97 offen sc1
    s_waitcnt vmcnt(8)
    v_mfma_f32_16x16x32_bf16 v[16:19], v[224:227], v[68:71], v[16:19]
    v_mfma_f32_16x16x32_bf16 v[20:23], v[228:231], v[68:71], v[20:23]
    v_mfma_f32_16x16x32_bf16 v[24:27], v[232:235], v[68:71], v[24:27]
    v_mfma_f32_16x16x32_bf16 v[28:31], v[236:239], v[68:71], v[28:31]
    s_add_u32 s97, s76, s64
    buffer_load_dwordx4 v[100:103], v11, s[28:31], s97 offen sc1
    s_waitcnt vmcnt(8)
    v_mfma_f32_16x16x32_bf16 v[44:47], v[128:131], v[72:75], 0
    v_mfma_f32_16x16x32_bf16 v[48:51], v[132:135], v[72:75], 0
    v_mfma_f32_16x16x32_bf16 v[52:55], v[136:139], v[72:75], 0
    v_mfma_f32_16x16x32_bf16 v[56:59], v[140:143], v[72:75], 0
    s_add_u32 s97, s76, s65
    buffer_load_dwordx4 v[104:107], v11, s[28:31], s97 offen sc1
    s_waitcnt vmcnt(8)
    v_mfma_f32_16x16x32_bf16 v[44:47], v[144:147], v[76:79], v[44:47]
    v_mfma_f32_16x16x32_bf16 v[48:51], v[148:151], v[76:79], v[48:51]
    v_mfma_f32_16x16x32_bf16 v[52:55], v[152:155], v[76:79], v[52:55]
    v_mfma_f32_16x16x32_bf16 v[56:59], v[156:159], v[76:79], v[56:59]
    s_add_u32 s97, s76, s66
    buffer_load_dwordx4 v[108:111], v11, s[28:31], s97 offen sc1
    s_waitcnt vmcnt(8)
    v_mfma_f32_16x16x32_bf16 v[44:47], v[160:163], v[80:83], v[44:47]
    v_mfma_f32_16x16x32_bf16 v[48:51], v[164:167], v[80:83], v[48:51]
    v_mfma_f32_16x16x32_bf16 v[52:55], v[168:171], v[80:83], v[52:55]
    v_mfma_f32_16x16x32_bf16 v[56:59], v[172:175], v[80:83], v[56:59]
    s_add_u32 s97, s76, s67
    buffer_load_dwordx4 v[112:115], v11, s[28:31], s97 offen sc1
    ds_write_b128 v9, v[16:19] offset:32768
    ds_write_b128 v10, v[20:23] offset:33792
    ds_write_b128 v9, v[24:27] offset:34816
    ds_write_b128 v10, v[28:31] offset:35840
    s_waitcnt vmcnt(8)
    v_mfma_f32_16x16x32_bf16 v[44:47], v[176:179], v[84:87], v[44:47]
    v_mfma_f32_16x16x32_bf16 v[48:51], v[180:183], v[84:87], v[48:51]
    v_mfma_f32_16x16x32_bf16 v[52:55], v[184:187], v[84:87], v[52:55]
    v_mfma_f32_16x16x32_bf16 v[56:59], v[188:191], v[84:87], v[56:59]
    s_add_u32 s97, s76, s68
    buffer_load_dwordx4 v[116:119], v11, s[28:31], s97 offen sc1
    s_waitcnt vmcnt(8)
    v_mfma_f32_16x16x32_bf16 v[44:47], v[192:195], v[88:91], v[44:47]
    v_mfma_f32_16x16x32_bf16 v[48:51], v[196:199], v[88:91], v[48:51]
    v_mfma_f32_16x16x32_bf16 v[52:55], v[200:203], v[88:91], v[52:55]
    v_mfma_f32_16x16x32_bf16 v[56:59], v[204:207], v[88:91], v[56:59]
    s_add_u32 s97, s76, s69
    buffer_load_dwordx4 v[120:123], v11, s[28:31], s97 offen sc1
    s_waitcnt vmcnt(8)
    v_mfma_f32_16x16x32_bf16 v[44:47], v[208:211], v[92:95], v[44:47]
    v_mfma_f32_16x16x32_bf16 v[48:51], v[212:215], v[92:95], v[48:51]
    v_mfma_f32_16x16x32_bf16 v[52:55], v[216:219], v[92:95], v[52:55]
    v_mfma_f32_16x16x32_bf16 v[56:59], v[220:223], v[92:95], v[56:59]
    s_add_u32 s97, s76, s70
    buffer_load_dwordx4 v[124:127], v11, s[28:31], s97 offen sc1
    s_cmp_lg_u32 s32, 0
    s_cbranch_scc1 W0_41
    s_waitcnt vmcnt(9)
    s_mov_b32 s62, 0
POLL_40:
    v_cmp_ne_u32 vcc, s90, v8
    s_add_u32 s62, s62, 1
    s_and_b32 s60, vcc_lo, 0xffffffff
    s_cbranch_scc0 W0_41
    s_cmp_ge_u32 s62, 0x4000
    s_cbranch_scc1 W0_41
    s_sleep 2
    v_lshlrev_b32 v8, 7, v1
    s_mov_b64 exec, 0xffffffff
    buffer_load_dword v8, v8, s[28:31], s91 offen sc1
    s_mov_b64 exec, -1
    s_waitcnt vmcnt(0)
    s_branch POLL_40
W0_41:
    s_cmp_lg_u32 s32, 0
    s_cbranch_scc1 W0_42
    v_lshrrev_b32 v4, 4, v1
    v_and_b32 v5, 15, v1
    v_mul_u32_u24 v6, 8320, v4
    v_lshl_add_u32 v6, v5, 4, v6
    s_mul_i32 s53, s58, 266240
    s_lshl_b32 s54, s57, 8
    s_add_u32 s53, s53, s54
    s_add_u32 s53, s53, 12582912
    s_waitcnt lgkmcnt(0)
    buffer_load_dwordx4 v[240:243], v6, s[28:31], s53 offen sc1
    s_add_u32 s53, s53, 33280
    buffer_load_dwordx4 v[244:247], v6, s[28:31], s53 offen sc1
    s_add_u32 s53, s53, 33280
    buffer_load_dwordx4 v[248:251], v6, s[28:31], s53 offen sc1
    s_add_u32 s53, s53, 33280
    buffer_load_dwordx4 v[252:255], v6, s[28:31], s53 offen sc1
    s_add_u32 s53, s53, 33280
    buffer_load_dwordx4 v[16:19], v6, s[28:31], s53 offen sc1
    s_add_u32 s53, s53, 33280
    buffer_load_dwordx4 v[20:23], v6, s[28:31], s53 offen sc1
    s_add_u32 s53, s53, 33280
    buffer_load_dwordx4 v[24:27], v6, s[28:31], s53 offen sc1
    s_add_u32 s53, s53, 33280
    buffer_load_dwordx4 v[28:31], v6, s[28:31], s53 offen sc1
    v_mul_u32_u24 v6, 272, v4
    v_lshl_add_u32 v6, v5, 4, v6
    v_add_u32 v6, 147968, v6
W0_42:
    s_lshr_b32 s53, s32, 1
    s_sub_u32 s53, s53, s58
    s_and_b32 s53, s53, 3
    s_lshl_b32 s54, s53, 15
    s_cmp_eq_u32 s53, 3
    s_cmov_b32 s54, 114688
    v_lshrrev_b32 v7, 3, v1
    s_and_b32 s53, s32, 1
    s_lshl_b32 s53, s53, 3
    v_add_u32 v3, s53, v7
    v_and_b32 v4, 3, v1
    v_lshl_add_u32 v3, v4, 2, v3
    v_and_b32 v3, 15, v3
    v_and_b32 v4, 1, v1
    v_lshl_add_u32 v3, v4, 5, v3
    v_lshlrev_b32 v3, 4, v3
    v_bfe_u32 v4, v1, 1, 2
    v_lshl_add_u32 v3, v4, 10, v3
    v_add_u32 v3, s54, v3
    v_and_b32 v4, 7, v1
    v_mul_u32_u24 v5, 1088, v4
    v_lshl_add_u32 v5, v7, 2, v5
    s_lshl_b32 s53, s32, 5
    s_add_u32 s53, s53, 147968
    v_add_u32 v5, s53, v5
    s_waitcnt vmcnt(7)
    v_mfma_f32_16x16x32_bf16 v[44:47], v[224:227], v[96:99], v[44:47]
    v_mfma_f32_16x16x32_bf16 v[48:51], v[228:231], v[96:99], v[48:51]
    v_mfma_f32_16x16x32_bf16 v[52:55], v[232:235], v[96:99], v[52:55]
    v_mfma_f32_16x16x32_bf16 v[56:59], v[236:239], v[96:99], v[56:59]
    s_waitcnt vmcnt(6)
    v_mfma_f32_16x16x32_bf16 v[72:75], v[128:131], v[100:103], 0
    v_mfma_f32_16x16x32_bf16 v[76:79], v[132:135], v[100:103], 0
    v_mfma_f32_16x16x32_bf16 v[80:83], v[136:139], v[100:103], 0
    v_mfma_f32_16x16x32_bf16 v[84:87], v[140:143], v[100:103], 0
    s_waitcnt vmcnt(5)
    v_mfma_f32_16x16x32_bf16 v[72:75], v[144:147], v[104:107], v[72:75]
    v_mfma_f32_16x16x32_bf16 v[76:79], v[148:151], v[104:107], v[76:79]
    v_mfma_f32_16x16x32_bf16 v[80:83], v[152:155], v[104:107], v[80:83]
    v_mfma_f32_16x16x32_bf16 v[84:87], v[156:159], v[104:107], v[84:87]
    s_waitcnt vmcnt(4)
    v_mfma_f32_16x16x32_bf16 v[72:75], v[160:163], v[108:111], v[72:75]
    v_mfma_f32_16x16x32_bf16 v[76:79], v[164:167], v[108:111], v[76:79]
    v_mfma_f32_16x16x32_bf16 v[80:83], v[168:171], v[108:111], v[80:83]
    v_mfma_f32_16x16x32_bf16 v[84:87], v[172:175], v[108:111], v[84:87]
    v_add_u32 v9, 0x10000, v9
    v_add_u32 v10, 0x10000, v10
    ds_write_b128 v9, v[44:47] offset:0
    ds_write_b128 v10, v[48:51] offset:1024
    ds_write_b128 v9, v[52:55] offset:2048
    ds_write_b128 v10, v[56:59] offset:3072
    s_waitcnt vmcnt(3)
    v_mfma_f32_16x16x32_bf16 v[72:75], v[176:179], v[112:115], v[72:75]
    v_mfma_f32_16x16x32_bf16 v[76:79], v[180:183], v[112:115], v[76:79]
    v_mfma_f32_16x16x32_bf16 v[80:83], v[184:187], v[112:115], v[80:83]
    v_mfma_f32_16x16x32_bf16 v[84:87], v[188:191], v[112:115], v[84:87]
    s_waitcnt vmcnt(2)
    v_mfma_f32_16x16x32_bf16 v[72:75], v[192:195], v[116:119], v[72:75]
    v_mfma_f32_16x16x32_bf16 v[76:79], v[196:199], v[116:119], v[76:79]
    v_mfma_f32_16x16x32_bf16 v[80:83], v[200:203], v[116:119], v[80:83]
    v_mfma_f32_16x16x32_bf16 v[84:87], v[204:207], v[116:119], v[84:87]
    s_waitcnt vmcnt(1)
    v_mfma_f32_16x16x32_bf16 v[72:75], v[208:211], v[120:123], v[72:75]
    v_mfma_f32_16x16x32_bf16 v[76:79], v[212:215], v[120:123], v[76:79]
    v_mfma_f32_16x16x32_bf16 v[80:83], v[216:219], v[120:123], v[80:83]
    v_mfma_f32_16x16x32_bf16 v[84:87], v[220:223], v[120:123], v[84:87]
    s_waitcnt vmcnt(0)
    v_mfma_f32_16x16x32_bf16 v[72:75], v[224:227], v[124:127], v[72:75]
    v_mfma_f32_16x16x32_bf16 v[76:79], v[228:231], v[124:127], v[76:79]
    v_mfma_f32_16x16x32_bf16 v[80:83], v[232:235], v[124:127], v[80:83]
    v_mfma_f32_16x16x32_bf16 v[84:87], v[236:239], v[124:127], v[84:87]
    s_nop 6
    ds_write_b128 v9, v[72:75] offset:49152
    ds_write_b128 v10, v[76:79] offset:50176
    ds_write_b128 v9, v[80:83] offset:51200
    ds_write_b128 v10, v[84:87] offset:52224
    s_cmp_lg_u32 s32, 0
    s_cbranch_scc1 W0_43
    s_waitcnt vmcnt(0)
    ds_write_b128 v6, v[240:243] offset:0
    ds_write_b128 v6, v[244:247] offset:1088
    ds_write_b128 v6, v[248:251] offset:2176
    ds_write_b128 v6, v[252:255] offset:3264
    ds_write_b128 v6, v[16:19] offset:4352
    ds_write_b128 v6, v[20:23] offset:5440
    ds_write_b128 v6, v[24:27] offset:6528
    ds_write_b128 v6, v[28:31] offset:7616
W0_43:
    v_lshlrev_b32 v88, 16, v32
    v_and_b32 v89, 0xffff0000, v32
    v_lshlrev_b32 v90, 16, v33
    v_and_b32 v91, 0xffff0000, v33
    v_lshlrev_b32 v92, 16, v34
    v_and_b32 v93, 0xffff0000, v34
    v_lshlrev_b32 v94, 16, v35
    v_and_b32 v95, 0xffff0000, v35
    s_waitcnt lgkmcnt(0)
    s_barrier
    ds_read_b32 v36, v5 offset:0
    ds_read_b32 v37, v5 offset:272
    ds_read_b32 v38, v5 offset:544
    ds_read_b32 v39, v5 offset:816
    ds_read_b128 v[128:131], v3 offset:0
    ds_read_b128 v[132:135], v3 offset:256
    ds_read_b128 v[136:139], v3 offset:4096
    ds_read_b128 v[140:143], v3 offset:4352
    ds_read_b128 v[144:147], v3 offset:8192
    ds_read_b128 v[148:151], v3 offset:8448
    ds_read_b128 v[152:155], v3 offset:12288
    ds_read_b128 v[156:159], v3 offset:12544
    ds_read_b128 v[160:163], v3 offset:16384
    ds_read_b128 v[164:167], v3 offset:16640
    ds_read_b128 v[168:171], v3 offset:20480
    ds_read_b128 v[172:175], v3 offset:20736
    ds_read_b128 v[176:179], v3 offset:24576
    ds_read_b128 v[180:183], v3 offset:24832
    ds_read_b128 v[184:187], v3 offset:28672
    ds_read_b128 v[188:191], v3 offset:28928
    s_waitcnt lgkmcnt(15)
    v_lshlrev_b32 v96, 16, v36
    v_and_b32 v97, 0xffff0000, v36
    v_lshlrev_b32 v98, 16, v37
    v_and_b32 v99, 0xffff0000, v37
    v_lshlrev_b32 v100, 16, v38
    v_and_b32 v101, 0xffff0000, v38
    v_lshlrev_b32 v102, 16, v39
    v_and_b32 v103, 0xffff0000, v39
    v_add_f32 v88, v88, v96
    v_add_f32 v89, v89, v97
    v_add_f32 v90, v90, v98
    v_add_f32 v91, v91, v99
    v_add_f32 v92, v92, v100
    v_add_f32 v93, v93, v101
    v_add_f32 v94, v94, v102
    v_add_f32 v95, v95, v103
    s_waitcnt lgkmcnt(12)
    v_pk_add_f32 v[128:129], v[128:129], v[136:137]
    v_pk_add_f32 v[130:131], v[130:131], v[138:139]
    v_pk_add_f32 v[132:133], v[132:133], v[140:141]
    v_pk_add_f32 v[134:135], v[134:135], v[142:143]
    s_waitcnt lgkmcnt(10)
    v_pk_add_f32 v[128:129], v[128:129], v[144:145]
    v_pk_add_f32 v[130:131], v[130:131], v[146:147]
    v_pk_add_f32 v[132:133], v[132:133], v[148:149]
    v_pk_add_f32 v[134:135], v[134:135], v[150:151]
    s_waitcnt lgkmcnt(8)
    v_pk_add_f32 v[128:129], v[128:129], v[152:153]
    v_pk_add_f32 v[130:131], v[130:131], v[154:155]
    v_pk_add_f32 v[132:133], v[132:133], v[156:157]
    v_pk_add_f32 v[134:135], v[134:135], v[158:159]
    s_waitcnt lgkmcnt(6)
    v_pk_add_f32 v[128:129], v[128:129], v[160:161]
    v_pk_add_f32 v[130:131], v[130:131], v[162:163]
    v_pk_add_f32 v[132:133], v[132:133], v[164:165]
    v_pk_add_f32 v[134:135], v[134:135], v[166:167]
    s_waitcnt lgkmcnt(4)
    v_pk_add_f32 v[128:129], v[128:129], v[168:169]
    v_pk_add_f32 v[130:131], v[130:131], v[170:171]
    v_pk_add_f32 v[132:133], v[132:133], v[172:173]
    v_pk_add_f32 v[134:135], v[134:135], v[174:175]
    s_waitcnt lgkmcnt(2)
    v_pk_add_f32 v[128:129], v[128:129], v[176:177]
    v_pk_add_f32 v[130:131], v[130:131], v[178:179]
    v_pk_add_f32 v[132:133], v[132:133], v[180:181]
    v_pk_add_f32 v[134:135], v[134:135], v[182:183]
    s_waitcnt lgkmcnt(0)
    v_pk_add_f32 v[128:129], v[128:129], v[184:185]
    v_pk_add_f32 v[130:131], v[130:131], v[186:187]
    v_pk_add_f32 v[132:133], v[132:133], v[188:189]
    v_pk_add_f32 v[134:135], v[134:135], v[190:191]
    v_cvt_pk_bf16_f32 v96, v88, v128
    v_cvt_pk_bf16_f32 v97, v89, v129
    v_cvt_pk_bf16_f32 v98, v90, v130
    v_cvt_pk_bf16_f32 v99, v91, v131
    v_cvt_pk_bf16_f32 v100, v92, v132
    v_cvt_pk_bf16_f32 v101, v93, v133
    v_cvt_pk_bf16_f32 v102, v94, v134
    v_cvt_pk_bf16_f32 v103, v95, v135
    v_lshlrev_b32 v88, 16, v96
    v_and_b32 v96, 0xffff0000, v96
    v_lshlrev_b32 v89, 16, v97
    v_and_b32 v97, 0xffff0000, v97
    v_lshlrev_b32 v90, 16, v98
    v_and_b32 v98, 0xffff0000, v98
    v_lshlrev_b32 v91, 16, v99
    v_and_b32 v99, 0xffff0000, v99
    v_lshlrev_b32 v92, 16, v100
    v_and_b32 v100, 0xffff0000, v100
    v_lshlrev_b32 v93, 16, v101
    v_and_b32 v101, 0xffff0000, v101
    v_lshlrev_b32 v94, 16, v102
    v_and_b32 v102, 0xffff0000, v102
    v_lshlrev_b32 v95, 16, v103
    v_and_b32 v103, 0xffff0000, v103
    v_add_f32 v88, v88, v96
    v_add_f32 v89, v89, v97
    v_add_f32 v90, v90, v98
    v_add_f32 v91, v91, v99
    v_add_f32 v92, v92, v100
    v_add_f32 v93, v93, v101
    v_add_f32 v94, v94, v102
    v_add_f32 v95, v95, v103
    v_cvt_pk_bf16_f32 v128, v88, v89
    v_cvt_pk_bf16_f32 v129, v90, v91
    v_cvt_pk_bf16_f32 v130, v92, v93
    v_cvt_pk_bf16_f32 v131, v94, v95
    buffer_store_dwordx4 v[128:131], v12, s[20:23], s77 offen
L_END:
    s_endpgm
.p2align 8
L_TAB:
.long 157184,157186,157442,157570,157954,157986,158018,158050,158210,158226,158242,158258,158338,158354,158370,158386
.long 158466,158474,158482,158490,158530,158538,158546,158554,158594,158602,158610,158618,158658,158666,158674,158682
.long 158722,158726,158730,158734,158754,158758,158762,158766,158786,158790,158794,158798,158818,158822,158826,158830
.long 158850,158854,158858,158862,158882,158886,158890,158894,158914,158918,158922,158926,158946,158950,158954,158958
.long 157698,157762,157826,157890,158082,158114,158146,158178,158274,158290,158306,158322,158402,158418,158434,158450
.long 158498,158506,158514,158522,158562,158570,158578,158586,158626,158634,158642,158650,158690,158698,158706,158714
.long 158738,158742,158746,158750,158770,158774,158778,158782,158802,158806,158810,158814,158834,158838,158842,158846
.long 158866,158870,158874,158878,158898,158902,158906,158910,158930,158934,158938,158942,158962,158966,158970,158974
.long 158978,158980,158982,158984,158994,158996,158998,159000,159010,159012,159014,159016,159026,159028,159030,159032
.long 159042,159044,159046,159048,159058,159060,159062,159064,159074,159076,159078,159080,159090,159092,159094,159096
.long 159106,159108,159110,159112,159122,159124,159126,159128,159138,159140,159142,159144,159154,159156,159158,159160
.long 159170,159172,159174,159176,159186,159188,159190,159192,159202,159204,159206,159208,159218,159220,159222,159224
.long 158986,158988,158990,158992,159002,159004,159006,159008,159018,159020,159022,159024,159034,159036,159038,159040
.long 159050,159052,159054,159056,159066,159068,159070,159072,159082,159084,159086,159088,159098,159100,159102,159104
.long 159114,159116,159118,159120,159130,159132,159134,159136,159146,159148,159150,159152,159162,159164,159166,159168
.long 159178,159180,159182,159184,159194,159196,159198,159200,159210,159212,159214,159216,159226,159228,159230,159232
.long 159746,159778,159810,159842,159748,159780,159812,159844,159750,159782,159814,159846,159752,159784,159816,159848
.long 159754,159786,159818,159850,159756,159788,159820,159852,159758,159790,159822,159854,159760,159792,159824,159856
.long 159762,159794,159826,159858,159764,159796,159828,159860,159766,159798,159830,159862,159768,159800,159832,159864
.long 159770,159802,159834,159866,159772,159804,159836,159868,159774,159806,159838,159870,159776,159808,159840,159872
.long 159874,159906,159938,159970,159876,159908,159940,159972,159878,159910,159942,159974,159880,159912,159944,159976
.long 159882,159914,159946,159978,159884,159916,159948,159980,159886,159918,159950,159982,159888,159920,159952,159984
.long 159890,159922,159954,159986,159892,159924,159956,159988,159894,159926,159958,159990,159896,159928,159960,159992
.long 159898,159930,159962,159994,159900,159932,159964,159996,159902,159934,159966,159998,159904,159936,159968,160000
.long 160002,160006,160006,160006,160006,160006,160006,160006,160006,160006,160006,160006,160006,160006,160006,160006
.long 160006,160006,160006,160006,160006,160006,160006,160006,160006,160006,160006,160006,160006,160006,160006,160006
.long 160006,160006,160006,160006,160006,160006,160006,160006,160006,160006,160006,160006,160006,160006,160006,160006
.long 160006,160006,160006,160006,160006,160006,160006,160006,160006,160006,160006,160006,160006,160006,160006,160006
.long 160006,160006,160006,160006,160006,160006,160006,160006,160006,160006,160006,160006,160006,160006,160006,160006
.long 160006,160006,160006,160006,160006,160006,160006,160006,160006,160006,160006,160006,160006,160006,160006,160006
.long 160006,160006,160006,160006,160006,160006,160006,160006,160006,160006,160006,160006,160006,160006,160006,160006
.long 160006,160006,160006,160006,160006,160006,160006,160006,160006,160006,160006,160006,160006,160006,160006,160006
.long 160256,160258,160514,160642,161026,161058,161090,161122,161282,161298,161314,161330,161410,161426,161442,161458
.long 161538,161546,161554,161562,161602,161610,161618,161626,161666,161674,161682,161690,161730,161738,161746,161754
.long 161794,161798,161802,161806,161826,161830,161834,161838,161858,161862,161866,161870,161890,161894,161898,161902
.long 161922,161926,161930,161934,161954,161958,161962,161966,161986,161990,161994,161998,162018,162022,162026,162030
.long 160770,160834,160898,160962,161154,161186,161218,161250,161346,161362,161378,161394,161474,161490,161506,161522
.long 161570,161578,161586,161594,161634,161642,161650,161658,161698,161706,161714,161722,161762,161770,161778,161786
.long 161810,161814,161818,161822,161842,161846,161850,161854,161874,161878,161882,161886,161906,161910,161914,161918
.long 161938,161942,161946,161950,161970,161974,161978,161982,162002,162006,162010,162014,162034,162038,162042,162046
.long 162050,162052,162054,162056,162066,162068,162070,162072,162082,162084,162086,162088,162098,162100,162102,162104
.long 162114,162116,162118,162120,162130,162132,162134,162136,162146,162148,162150,162152,162162,162164,162166,162168
.long 162178,162180,162182,162184,162194,162196,162198,162200,162210,162212,162214,162216,162226,162228,162230,162232
.long 162242,162244,162246,162248,162258,162260,162262,162264,162274,162276,162278,162280,162290,162292,162294,162296
.long 162058,162060,162062,162064,162074,162076,162078,162080,162090,162092,162094,162096,162106,162108,162110,162112
.long 162122,162124,162126,162128,162138,162140,162142,162144,162154,162156,162158,162160,162170,162172,162174,162176
.long 162186,162188,162190,162192,162202,162204,162206,162208,162218,162220,162222,162224,162234,162236,162238,162240
.long 162250,162252,162254,162256,162266,162268,162270,162272,162282,162284,162286,162288,162298,162300,162302,162304
.long 162818,162850,162882,162914,162820,162852,162884,162916,162822,162854,162886,162918,162824,162856,162888,162920
.long 162826,162858,162890,162922,162828,162860,162892,162924,162830,162862,162894,162926,162832,162864,162896,162928
.long 162834,162866,162898,162930,162836,162868,162900,162932,162838,162870,162902,162934,162840,162872,162904,162936
.long 162842,162874,162906,162938,162844,162876,162908,162940,162846,162878,162910,162942,162848,162880,162912,162944
.long 162946,162978,163010,163042,162948,162980,163012,163044,162950,162982,163014,163046,162952,162984,163016,163048
.long 162954,162986,163018,163050,162956,162988,163020,163052,162958,162990,163022,163054,162960,162992,163024,163056
.long 162962,162994,163026,163058,162964,162996,163028,163060,162966,162998,163030,163062,162968,163000,163032,163064
.long 162970,163002,163034,163066,162972,163004,163036,163068,162974,163006,163038,163070,162976,163008,163040,163072
.long 163074,163078,163078,163078,163078,163078,163078,163078,163078,163078,163078,163078,163078,163078,163078,163078
.long 163078,163078,163078,163078,163078,163078,163078,163078,163078,163078,163078,163078,163078,163078,163078,163078
.long 163078,163078,163078,163078,163078,163078,163078,163078,163078,163078,163078,163078,163078,163078,163078,163078
.long 163078,163078,163078,163078,163078,163078,163078,163078,163078,163078,163078,163078,163078,163078,163078,163078
.long 163078,163078,163078,163078,163078,163078,163078,163078,163078,163078,163078,163078,163078,163078,163078,163078
.long 163078,163078,163078,163078,163078,163078,163078,163078,163078,163078,163078,163078,163078,163078,163078,163078
.long 163078,163078,163078,163078,163078,163078,163078,163078,163078,163078,163078,163078,163078,163078,163078,163078
.long 163078,163078,163078,163078,163078,163078,163078,163078,163078,163078,163078,163078,163078,163078,163078,163078
.long 159234,159236,159238,159240,159242,159244,159246,159248,159250,159252,159254,159256,159258,159260,159262,159264
.long 159266,159268,159270,159272,159274,159276,159278,159280,159282,159284,159286,159288,159290,159292,159294,159296
.long 159298,159300,159302,159304,159306,159308,159310,159312,159314,159316,159318,159320,159322,159324,159326,159328
.long 159330,159332,159334,159336,159338,159340,159342,159344,159346,159348,159350,159352,159354,159356,159358,159360
.long 159362,159364,159366,159368,159370,159372,159374,159376,159378,159380,159382,159384,159386,159388,159390,159392
.long 159394,159396,159398,159400,159402,159404,159406,159408,159410,159412,159414,159416,159418,159420,159422,159424
.long 159426,159428,159430,159432,159434,159436,159438,159440,159442,159444,159446,159448,159450,159452,159454,159456
.long 159458,159460,159462,159464,159466,159468,159470,159472,159474,159476,159478,159480,159482,159484,159486,159488
.long 159490,159554,159618,159682,159494,159558,159622,159686,159498,159562,159626,159690,159502,159566,159630,159694
.long 159506,159570,159634,159698,159510,159574,159638,159702,159514,159578,159642,159706,159518,159582,159646,159710
.long 159522,159586,159650,159714,159526,159590,159654,159718,159530,159594,159658,159722,159534,159598,159662,159726
.long 159538,159602,159666,159730,159542,159606,159670,159734,159546,159610,159674,159738,159550,159614,159678,159742
.long 159492,159556,159620,159684,159496,159560,159624,159688,159500,159564,159628,159692,159504,159568,159632,159696
.long 159508,159572,159636,159700,159512,159576,159640,159704,159516,159580,159644,159708,159520,159584,159648,159712
.long 159524,159588,159652,159716,159528,159592,159656,159720,159532,159596,159660,159724,159536,159600,159664,159728
.long 159540,159604,159668,159732,159544,159608,159672,159736,159548,159612,159676,159740,159552,159616,159680,159744
.long 160006,160006,160006,160006,160006,160006,160006,160006,160006,160006,160006,160006,160006,160006,160006,160006
.long 160006,160006,160006,160006,160006,160006,160006,160006,160006,160006,160006,160006,160006,160006,160006,160006
.long 160006,160006,160006,160006,160006,160006,160006,160006,160006,160006,160006,160006,160006,160006,160006,160006
.long 160006,160006,160006,160006,160006,160006,160006,160006,160006,160006,160006,160006,160006,160006,160006,160006
.long 160006,160006,160006,160006,160006,160006,160006,160006,160006,160006,160006,160006,160006,160006,160006,160006
.long 160006,160006,160006,160006,160006,160006,160006,160006,160006,160006,160006,160006,160006,160006,160006,160006
.long 160006,160006,160006,160006,160006,160006,160006,160006,160006,160006,160006,160006,160006,160006,160006,160006
.long 160006,160006,160006,160006,160006,160006,160006,160006,160006,160006,160006,160006,160006,160006,160006,160006
.long 160006,160006,160006,160006,160006,160006,160006,160006,160006,160006,160006,160006,160006,160006,160006,160006
.long 160006,160006,160006,160006,160006,160006,160006,160006,160006,160006,160006,160006,160006,160006,160006,160006
.long 160006,160006,160006,160006,160006,160006,160006,160006,160006,160006,160006,160006,160006,160006,160006,160006
.long 160006,160006,160006,160006,160006,160006,160006,160006,160006,160006,160006,160006,160006,160006,160006,160006
.long 160006,160006,160006,160006,160006,160006,160006,160006,160006,160006,160006,160006,160006,160006,160006,160006
.long 160006,160006,160006,160006,160006,160006,160006,160006,160006,160006,160006,160006,160006,160006,160006,160006
.long 160006,160006,160006,160006,160006,160006,160006,160006,160006,160006,160006,160006,160006,160006,160006,160006
.long 160006,160006,160006,160006,160006,160006,160006,160006,160006,160006,160006,160006,160006,160006,160006,160006
.long 162306,162308,162310,162312,162314,162316,162318,162320,162322,162324,162326,162328,162330,162332,162334,162336
.long 162338,162340,162342,162344,162346,162348,162350,162352,162354,162356,162358,162360,162362,162364,162366,162368
.long 162370,162372,162374,162376,162378,162380,162382,162384,162386,162388,162390,162392,162394,162396,162398,162400
.long 162402,162404,162406,162408,162410,162412,162414,162416,162418,162420,162422,162424,162426,162428,162430,162432
.long 162434,162436,162438,162440,162442,162444,162446,162448,162450,162452,162454,162456,162458,162460,162462,162464
.long 162466,162468,162470,162472,162474,162476,162478,162480,162482,162484,162486,162488,162490,162492,162494,162496
.long 162498,162500,162502,162504,162506,162508,162510,162512,162514,162516,162518,162520,162522,162524,162526,162528
.long 162530,162532,162534,162536,162538,162540,162542,162544,162546,162548,162550,162552,162554,162556,162558,162560
.long 162562,162626,162690,162754,162566,162630,162694,162758,162570,162634,162698,162762,162574,162638,162702,162766
.long 162578,162642,162706,162770,162582,162646,162710,162774,162586,162650,162714,162778,162590,162654,162718,162782
.long 162594,162658,162722,162786,162598,162662,162726,162790,162602,162666,162730,162794,162606,162670,162734,162798
.long 162610,162674,162738,162802,162614,162678,162742,162806,162618,162682,162746,162810,162622,162686,162750,162814
.long 162564,162628,162692,162756,162568,162632,162696,162760,162572,162636,162700,162764,162576,162640,162704,162768
.long 162580,162644,162708,162772,162584,162648,162712,162776,162588,162652,162716,162780,162592,162656,162720,162784
.long 162596,162660,162724,162788,162600,162664,162728,162792,162604,162668,162732,162796,162608,162672,162736,162800
.long 162612,162676,162740,162804,162616,162680,162744,162808,162620,162684,162748,162812,162624,162688,162752,162816
.long 163078,163078,163078,163078,163078,163078,163078,163078,163078,163078,163078,163078,163078,163078,163078,163078
.long 163078,163078,163078,163078,163078,163078,163078,163078,163078,163078,163078,163078,163078,163078,163078,163078
.long 163078,163078,163078,163078,163078,163078,163078,163078,163078,163078,163078,163078,163078,163078,163078,163078
.long 163078,163078,163078,163078,163078,163078,163078,163078,163078,163078,163078,163078,163078,163078,163078,163078
.long 163078,163078,163078,163078,163078,163078,163078,163078,163078,163078,163078,163078,163078,163078,163078,163078
.long 163078,163078,163078,163078,163078,163078,163078,163078,163078,163078,163078,163078,163078,163078,163078,163078
.long 163078,163078,163078,163078,163078,163078,163078,163078,163078,163078,163078,163078,163078,163078,163078,163078
.long 163078,163078,163078,163078,163078,163078,163078,163078,163078,163078,163078,163078,163078,163078,163078,163078
.long 163078,163078,163078,163078,163078,163078,163078,163078,163078,163078,163078,163078,163078,163078,163078,163078
.long 163078,163078,163078,163078,163078,163078,163078,163078,163078,163078,163078,163078,163078,163078,163078,163078
.long 163078,163078,163078,163078,163078,163078,163078,163078,163078,163078,163078,163078,163078,163078,163078,163078
.long 163078,163078,163078,163078,163078,163078,163078,163078,163078,163078,163078,163078,163078,163078,163078,163078
.long 163078,163078,163078,163078,163078,163078,163078,163078,163078,163078,163078,163078,163078,163078,163078,163078
.long 163078,163078,163078,163078,163078,163078,163078,163078,163078,163078,163078,163078,163078,163078,163078,163078
.long 163078,163078,163078,163078,163078,163078,163078,163078,163078,163078,163078,163078,163078,163078,163078,163078
.long 163078,163078,163078,163078,163078,163078,163078,163078,163078,163078,163078,163078,163078,163078,163078,163078
.long 160002,160002,160002,160002,160000,160000,160000,159998,159998,159998,159998,159998,159996,159996,159996,159994
.long 159994,159994,159994,159994,159992,159992,159992,159990,159990,159990,159990,159990,159988,159988,159988,159986
.long 159986,159986,159986,159986,159984,159984,159984,159982,159982,159982,159982,159982,159980,159980,159980,159978
.long 159978,159978,159978,159978,159976,159976,159976,159974,159974,159974,159974,159974,159972,159972,159972,159970
.long 159970,159970,159970,159970,159968,159968,159968,159966,159966,159966,159966,159966,159964,159964,159964,159962
.long 159962,159962,159962,159962,159960,159960,159960,159958,159958,159958,159958,159958,159956,159956,159956,159954
.long 159954,159954,159954,159954,159952,159952,159952,159950,159950,159950,159950,159950,159948,159948,159948,159946
.long 159946,159946,159946,159946,159944,159944,159944,159942,159942,159942,159942,159942,159940,159940,159940,159938
.long 159938,159938,159938,159938,159936,159936,159936,159934,159934,159934,159934,159934,159932,159932,159932,159930
.long 159930,159930,159930,159930,159928,159928,159928,159926,159926,159926,159926,159926,159924,159924,159924,159922
.long 159922,159922,159922,159922,159920,159920,159920,159918,159918,159918,159918,159918,159916,159916,159916,159914
.long 159914,159914,159914,159914,159912,159912,159912,159910,159910,159910,159910,159910,159908,159908,159908,159906
.long 159906,159906,159906,159906,159904,159904,159904,159902,159902,159902,159902,159902,159900,159900,159900,159898
.long 159898,159898,159898,159898,159896,159896,159896,159894,159894,159894,159894,159894,159892,159892,159892,159890
.long 159890,159890,159890,159890,159888,159888,159888,159886,159886,159886,159886,159886,159884,159884,159884,159882
.long 159882,159882,159882,159882,159880,159880,159880,159878,159878,159878,159878,159878,159876,159876,159876,159874
.long 159874,159874,159874,159874,159872,159872,159872,159870,159870,159870,159870,159870,159868,159868,159868,159866
.long 159866,159866,159866,159866,159864,159864,159864,159862,159862,159862,159862,159862,159860,159860,159860,159858
.long 159858,159858,159858,159858,159856,159856,159856,159854,159854,159854,159854,159854,159852,159852,159852,159850
.long 159850,159850,159850,159850,159848,159848,159848,159846,159846,159846,159846,159846,159844,159844,159844,159842
.long 159842,159842,159842,159842,159840,159840,159840,159838,159838,159838,159838,159838,159836,159836,159836,159834
.long 159834,159834,159834,159834,159832,159832,159832,159830,159830,159830,159830,159830,159828,159828,159828,159826
.long 159826,159826,159826,159826,159824,159824,159824,159822,159822,159822,159822,159822,159820,159820,159820,159818
.long 159818,159818,159818,159818,159816,159816,159816,159814,159814,159814,159814,159814,159812,159812,159812,159810
.long 159810,159810,159810,159810,159808,159808,159808,159806,159806,159806,159806,159806,159804,159804,159804,159802
.long 159802,159802,159802,159802,159800,159800,159800,159798,159798,159798,159798,159798,159796,159796,159796,159794
.long 159794,159794,159794,159794,159792,159792,159792,159790,159790,159790,159790,159790,159788,159788,159788,159786
.long 159786,159786,159786,159786,159784,159784,159784,159782,159782,159782,159782,159782,159780,159780,159780,159778
.long 159778,159778,159778,159778,159776,159776,159776,159774,159774,159774,159774,159774,159772,159772,159772,159770
.long 159770,159770,159770,159770,159768,159768,159768,159766,159766,159766,159766,159766,159764,159764,159764,159762
.long 159762,159762,159762,159762,159760,159760,159760,159758,159758,159758,159758,159758,159756,159756,159756,159754
.long 159754,159754,159754,159754,159752,159752,159752,159750,159750,159750,159750,159750,159748,159748,159748,159746
.long 159746,159746,159744,159744,159742,159742,159740,159740,159738,159738,159736,159736,159734,159734,159732,159732
.long 159730,159730,159728,159728,159726,159726,159724,159724,159722,159722,159720,159720,159718,159718,159716,159716
.long 159714,159714,159712,159712,159710,159710,159708,159708,159706,159706,159704,159704,159702,159702,159700,159700
.long 159698,159698,159696,159696,159694,159694,159692,159692,159690,159690,159688,159688,159686,159686,159684,159684
.long 159682,159682,159680,159680,159678,159678,159676,159676,159674,159674,159672,159672,159670,159670,159668,159668
.long 159666,159666,159664,159664,159662,159662,159660,159660,159658,159658,159656,159656,159654,159654,159652,159652
.long 159650,159650,159648,159648,159646,159646,159644,159644,159642,159642,159640,159640,159638,159638,159636,159636
.long 159634,159634,159632,159632,159630,159630,159628,159628,159626,159626,159624,159624,159622,159622,159620,159620
.long 159618,159618,159616,159616,159614,159614,159612,159612,159610,159610,159608,159608,159606,159606,159604,159604
.long 159602,159602,159600,159600,159598,159598,159596,159596,159594,159594,159592,159592,159590,159590,159588,159588
.long 159586,159586,159584,159584,159582,159582,159580,159580,159578,159578,159576,159576,159574,159574,159572,159572
.long 159570,159570,159568,159568,159566,159566,159564,159564,159562,159562,159560,159560,159558,159558,159556,159556
.long 159554,159554,159552,159552,159550,159550,159548,159548,159546,159546,159544,159544,159542,159542,159540,159540
.long 159538,159538,159536,159536,159534,159534,159532,159532,159530,159530,159528,159528,159526,159526,159524,159524
.long 159522,159522,159520,159520,159518,159518,159516,159516,159514,159514,159512,159512,159510,159510,159508,159508
.long 159506,159506,159504,159504,159502,159502,159500,159500,159498,159498,159496,159496,159494,159494,159492,159492
.long 159490,159488,159486,159486,159482,159480,159478,159478,159474,159472,159470,159470,159466,159464,159462,159462
.long 159458,159456,159454,159454,159450,159448,159446,159446,159442,159440,159438,159438,159434,159432,159430,159430
.long 159426,159424,159422,159422,159418,159416,159414,159414,159410,159408,159406,159406,159402,159400,159398,159398
.long 159394,159392,159390,159390,159386,159384,159382,159382,159378,159376,159374,159374,159370,159368,159366,159366
.long 159362,159360,159358,159358,159354,159352,159350,159350,159346,159344,159342,159342,159338,159336,159334,159334
.long 159330,159328,159326,159326,159322,159320,159318,159318,159314,159312,159310,159310,159306,159304,159302,159302
.long 159298,159296,159294,159294,159290,159288,159286,159286,159282,159280,159278,159278,159274,159272,159270,159270
.long 159266,159264,159262,159262,159258,159256,159254,159254,159250,159248,159246,159246,159242,159240,159238,159238
.long 159232,159230,159228,159226,159216,159214,159212,159210,159200,159198,159196,159194,159184,159182,159180,159178
.long 159168,159166,159164,159162,159152,159150,159148,159146,159136,159134,159132,159130,159120,159118,159116,159114
.long 159104,159102,159100,159098,159088,159086,159084,159082,159072,159070,159068,159066,159056,159054,159052,159050
.long 159040,159038,159036,159034,159024,159022,159020,159018,159008,159006,159004,159002,158992,158990,158988,158986
.long 158974,158970,158966,158962,158942,158938,158934,158930,158910,158906,158902,158898,158878,158874,158870,158866
.long 158846,158842,158838,158834,158814,158810,158806,158802,158782,158778,158774,158770,158750,158746,158742,158738
.long 158714,158706,158698,158690,158650,158642,158634,158626,158586,158578,158570,158562,158522,158514,158506,158498
.long 158450,158434,158418,158402,158322,158306,158290,158274,158178,158146,158114,158082,157890,157826,157762,157698
.long 160000,160000,160000,160000,159998,159998,159998,159998,159996,159996,159996,159996,159994,159994,159994,159994
.long 159992,159992,159992,159992,159990,159990,159990,159990,159988,159988,159988,159988,159986,159986,159986,159986
.long 159984,159984,159984,159984,159982,159982,159982,159982,159980,159980,159980,159980,159978,159978,159978,159978
.long 159976,159976,159976,159976,159974,159974,159974,159974,159972,159972,159972,159972,159970,159970,159970,159970
.long 159968,159968,159968,159968,159966,159966,159966,159966,159964,159964,159964,159964,159962,159962,159962,159962
.long 159960,159960,159960,159960,159958,159958,159958,159958,159956,159956,159956,159956,159954,159954,159954,159954
.long 159952,159952,159952,159952,159950,159950,159950,159950,159948,159948,159948,159948,159946,159946,159946,159946
.long 159944,159944,159944,159944,159942,159942,159942,159942,159940,159940,159940,159940,159938,159938,159938,159938
.long 159936,159936,159936,159936,159934,159934,159934,159934,159932,159932,159932,159932,159930,159930,159930,159930
.long 159928,159928,159928,159928,159926,159926,159926,159926,159924,159924,159924,159924,159922,159922,159922,159922
.long 159920,159920,159920,159920,159918,159918,159918,159918,159916,159916,159916,159916,159914,159914,159914,159914
.long 159912,159912,159912,159912,159910,159910,159910,159910,159908,159908,159908,159908,159906,159906,159906,159906
.long 159904,159904,159904,159904,159902,159902,159902,159902,159900,159900,159900,159900,159898,159898,159898,159898
.long 159896,159896,159896,159896,159894,159894,159894,159894,159892,159892,159892,159892,159890,159890,159890,159890
.long 159888,159888,159888,159888,159886,159886,159886,159886,159884,159884,159884,159884,159882,159882,159882,159882
.long 159880,159880,159880,159880,159878,159878,159878,159878,159876,159876,159876,159876,159874,159874,159874,159874
.long 159872,159872,159872,159872,159870,159870,159870,159870,159868,159868,159868,159868,159866,159866,159866,159866
.long 159864,159864,159864,159864,159862,159862,159862,159862,159860,159860,159860,159860,159858,159858,159858,159858
.long 159856,159856,159856,159856,159854,159854,159854,159854,159852,159852,159852,159852,159850,159850,159850,159850
.long 159848,159848,159848,159848,159846,159846,159846,159846,159844,159844,159844,159844,159842,159842,159842,159842
.long 159840,159840,159840,159840,159838,159838,159838,159838,159836,159836,159836,159836,159834,159834,159834,159834
.long 159832,159832,159832,159832,159830,159830,159830,159830,159828,159828,159828,159828,159826,159826,159826,159826
.long 159824,159824,159824,159824,159822,159822,159822,159822,159820,159820,159820,159820,159818,159818,159818,159818
.long 159816,159816,159816,159816,159814,159814,159814,159814,159812,159812,159812,159812,159810,159810,159810,159810
.long 159808,159808,159808,159808,159806,159806,159806,159806,159804,159804,159804,159804,159802,159802,159802,159802
.long 159800,159800,159800,159800,159798,159798,159798,159798,159796,159796,159796,159796,159794,159794,159794,159794
.long 159792,159792,159792,159792,159790,159790,159790,159790,159788,159788,159788,159788,159786,159786,159786,159786
.long 159784,159784,159784,159784,159782,159782,159782,159782,159780,159780,159780,159780,159778,159778,159778,159778
.long 159776,159776,159776,159776,159774,159774,159774,159774,159772,159772,159772,159772,159770,159770,159770,159770
.long 159768,159768,159768,159768,159766,159766,159766,159766,159764,159764,159764,159764,159762,159762,159762,159762
.long 159760,159760,159760,159760,159758,159758,159758,159758,159756,159756,159756,159756,159754,159754,159754,159754
.long 159752,159752,159752,159752,159750,159750,159750,159750,159748,159748,159748,159748,159746,159746,159746,159746
.long 159744,159742,159742,159742,159740,159738,159738,159738,159736,159734,159734,159734,159732,159730,159730,159730
.long 159728,159726,159726,159726,159724,159722,159722,159722,159720,159718,159718,159718,159716,159714,159714,159714
.long 159712,159710,159710,159710,159708,159706,159706,159706,159704,159702,159702,159702,159700,159698,159698,159698
.long 159696,159694,159694,159694,159692,159690,159690,159690,159688,159686,159686,159686,159684,159682,159682,159682
.long 159680,159678,159678,159678,159676,159674,159674,159674,159672,159670,159670,159670,159668,159666,159666,159666
.long 159664,159662,159662,159662,159660,159658,159658,159658,159656,159654,159654,159654,159652,159650,159650,159650
.long 159648,159646,159646,159646,159644,159642,159642,159642,159640,159638,159638,159638,159636,159634,159634,159634
.long 159632,159630,159630,159630,159628,159626,159626,159626,159624,159622,159622,159622,159620,159618,159618,159618
.long 159616,159614,159614,159614,159612,159610,159610,159610,159608,159606,159606,159606,159604,159602,159602,159602
.long 159600,159598,159598,159598,159596,159594,159594,159594,159592,159590,159590,159590,159588,159586,159586,159586
.long 159584,159582,159582,159582,159580,159578,159578,159578,159576,159574,159574,159574,159572,159570,159570,159570
.long 159568,159566,159566,159566,159564,159562,159562,159562,159560,159558,159558,159558,159556,159554,159554,159554
.long 159552,159550,159550,159550,159548,159546,159546,159546,159544,159542,159542,159542,159540,159538,159538,159538
.long 159536,159534,159534,159534,159532,159530,159530,159530,159528,159526,159526,159526,159524,159522,159522,159522
.long 159520,159518,159518,159518,159516,159514,159514,159514,159512,159510,159510,159510,159508,159506,159506,159506
.long 159504,159502,159502,159502,159500,159498,159498,159498,159496,159494,159494,159494,159492,159490,159490,159490
.long 159486,159484,159482,159482,159478,159476,159474,159474,159470,159468,159466,159466,159462,159460,159458,159458
.long 159454,159452,159450,159450,159446,159444,159442,159442,159438,159436,159434,159434,159430,159428,159426,159426
.long 159422,159420,159418,159418,159414,159412,159410,159410,159406,159404,159402,159402,159398,159396,159394,159394
.long 159390,159388,159386,159386,159382,159380,159378,159378,159374,159372,159370,159370,159366,159364,159362,159362
.long 159358,159356,159354,159354,159350,159348,159346,159346,159342,159340,159338,159338,159334,159332,159330,159330
.long 159326,159324,159322,159322,159318,159316,159314,159314,159310,159308,159306,159306,159302,159300,159298,159298
.long 159294,159292,159290,159290,159286,159284,159282,159282,159278,159276,159274,159274,159270,159268,159266,159266
.long 159262,159260,159258,159258,159254,159252,159250,159250,159246,159244,159242,159242,159238,159236,159234,159234
.long 159224,159222,159220,159218,159208,159206,159204,159202,159192,159190,159188,159186,159176,159174,159172,159170
.long 159160,159158,159156,159154,159144,159142,159140,159138,159128,159126,159124,159122,159112,159110,159108,159106
.long 159096,159094,159092,159090,159080,159078,159076,159074,159064,159062,159060,159058,159048,159046,159044,159042
.long 159032,159030,159028,159026,159016,159014,159012,159010,159000,158998,158996,158994,158984,158982,158980,158978
.long 158958,158954,158950,158946,158926,158922,158918,158914,158894,158890,158886,158882,158862,158858,158854,158850
.long 158830,158826,158822,158818,158798,158794,158790,158786,158766,158762,158758,158754,158734,158730,158726,158722
.long 158682,158674,158666,158658,158618,158610,158602,158594,158554,158546,158538,158530,158490,158482,158474,158466
.long 158386,158370,158354,158338,158258,158242,158226,158210,158050,158018,157986,157954,157570,157442,157186,157184
.long 160000,160000,160000,114688,159998,159998,159998,114704,159996,159996,159996,114720,159994,159994,159994,114736
.long 159992,159992,159992,114752,159990,159990,159990,114768,159988,159988,159988,114784,159986,159986,159986,114800
.long 159984,159984,159984,114816,159982,159982,159982,114832,159980,159980,159980,114848,159978,159978,159978,114864
.long 159976,159976,159976,114880,159974,159974,159974,114896,159972,159972,159972,114912,159970,159970,159970,114928
.long 159968,159968,159968,114944,159966,159966,159966,114960,159964,159964,159964,114976,159962,159962,159962,114992
.long 159960,159960,159960,115008,159958,159958,159958,115024,159956,159956,159956,115040,159954,159954,159954,115056
.long 159952,159952,159952,115072,159950,159950,159950,115088,159948,159948,159948,115104,159946,159946,159946,115120
.long 159944,159944,159944,115136,159942,159942,159942,115152,159940,159940,159940,115168,159938,159938,159938,115184
.long 159936,159936,159936,115200,159934,159934,159934,115216,159932,159932,159932,115232,159930,159930,159930,115248
.long 159928,159928,159928,115264,159926,159926,159926,115280,159924,159924,159924,115296,159922,159922,159922,115312
.long 159920,159920,159920,115328,159918,159918,159918,115344,159916,159916,159916,115360,159914,159914,159914,115376
.long 159912,159912,159912,115392,159910,159910,159910,115408,159908,159908,159908,115424,159906,159906,159906,115440
.long 159904,159904,159904,115456,159902,159902,159902,115472,159900,159900,159900,115488,159898,159898,159898,115504
.long 159896,159896,159896,115520,159894,159894,159894,115536,159892,159892,159892,115552,159890,159890,159890,115568
.long 159888,159888,159888,115584,159886,159886,159886,115600,159884,159884,159884,115616,159882,159882,159882,115632
.long 159880,159880,159880,115648,159878,159878,159878,115664,159876,159876,159876,115680,159874,159874,159874,115696
.long 159872,159872,159872,115712,159870,159870,159870,115728,159868,159868,159868,115744,159866,159866,159866,115760
.long 159864,159864,159864,115776,159862,159862,159862,115792,159860,159860,159860,115808,159858,159858,159858,115824
.long 159856,159856,159856,115840,159854,159854,159854,115856,159852,159852,159852,115872,159850,159850,159850,115888
.long 159848,159848,159848,115904,159846,159846,159846,115920,159844,159844,159844,115936,159842,159842,159842,115952
.long 159840,159840,159840,115968,159838,159838,159838,115984,159836,159836,159836,116000,159834,159834,159834,116016
.long 159832,159832,159832,116032,159830,159830,159830,116048,159828,159828,159828,116064,159826,159826,159826,116080
.long 159824,159824,159824,116096,159822,159822,159822,116112,159820,159820,159820,116128,159818,159818,159818,116144
.long 159816,159816,159816,116160,159814,159814,159814,116176,159812,159812,159812,116192,159810,159810,159810,116208
.long 159808,159808,159808,116224,159806,159806,159806,116240,159804,159804,159804,116256,159802,159802,159802,116272
.long 159800,159800,159800,116288,159798,159798,159798,116304,159796,159796,159796,116320,159794,159794,159794,116336
.long 159792,159792,159792,116352,159790,159790,159790,116368,159788,159788,159788,116384,159786,159786,159786,116400
.long 159784,159784,159784,116416,159782,159782,159782,116432,159780,159780,159780,116448,159778,159778,159778,116464
.long 159776,159776,159776,116480,159774,159774,159774,116496,159772,159772,159772,116512,159770,159770,159770,116528
.long 159768,159768,159768,116544,159766,159766,159766,116560,159764,159764,159764,116576,159762,159762,159762,116592
.long 159760,159760,159760,116608,159758,159758,159758,116624,159756,159756,159756,116640,159754,159754,159754,116656
.long 159752,159752,159752,116672,159750,159750,159750,116688,159748,159748,159748,116704,159746,159746,159744,116720
.long 159742,159742,159740,116736,159738,159738,159736,116752,159734,159734,159732,116768,159730,159730,159728,116784
.long 159726,159726,159724,116800,159722,159722,159720,116816,159718,159718,159716,116832,159714,159714,159712,116848
.long 159710,159710,159708,116864,159706,159706,159704,116880,159702,159702,159700,116896,159698,159698,159696,116912
.long 159694,159694,159692,116928,159690,159690,159688,116944,159686,159686,159684,116960,159682,159682,159680,116976
.long 159678,159678,159676,116992,159674,159674,159672,117008,159670,159670,159668,117024,159666,159666,159664,117040
.long 159662,159662,159660,117056,159658,159658,159656,117072,159654,159654,159652,117088,159650,159650,159648,117104
.long 159646,159646,159644,117120,159642,159642,159640,117136,159638,159638,159636,117152,159634,159634,159632,117168
.long 159630,159630,159628,117184,159626,159626,159624,117200,159622,159622,159620,117216,159618,159618,159616,117232
.long 159614,159614,159612,117248,159610,159610,159608,117264,159606,159606,159604,117280,159602,159602,159600,117296
.long 159598,159598,159596,117312,159594,159594,159592,117328,159590,159590,159588,117344,159586,159586,159584,117360
.long 159582,159582,159580,117376,159578,159578,159576,117392,159574,159574,159572,117408,159570,159570,159568,117424
.long 159566,159566,159564,117440,159562,159562,159560,117456,159558,159558,159556,117472,159554,159554,159552,117488
.long 159550,159550,159548,117504,159546,159546,159544,117520,159542,159542,159540,117536,159538,159538,159536,117552
.long 159534,159534,159532,117568,159530,159530,159528,117584,159526,159526,159524,117600,159522,159522,159520,117616
.long 159518,159518,159516,117632,159514,159514,159512,117648,159510,159510,159508,117664,159506,159506,159504,117680
.long 159502,159502,159500,117696,159498,159498,159496,117712,159494,159494,159492,117728,159490,159488,159486,117744
.long 159482,159480,159478,117760,159474,159472,159470,117776,159466,159464,159462,117792,159458,159456,159454,117808
.long 159450,159448,159446,117824,159442,159440,159438,117840,159434,159432,159430,117856,159426,159424,159422,117872
.long 159418,159416,159414,117888,159410,159408,159406,117904,159402,159400,159398,117920,159394,159392,159390,117936
.long 159386,159384,159382,117952,159378,159376,159374,117968,159370,159368,159366,117984,159362,159360,159358,118000
.long 159354,159352,159350,118016,159346,159344,159342,118032,159338,159336,159334,118048,159330,159328,159326,118064
.long 159322,159320,159318,118080,159314,159312,159310,118096,159306,159304,159302,118112,159298,159296,159294,118128
.long 159290,159288,159286,118144,159282,159280,159278,118160,159274,159272,159270,118176,159266,159264,159262,118192
.long 159258,159256,159254,118208,159250,159248,159246,118224,159242,159240,159238,118240,159232,159230,159228,118256
.long 159216,159214,159212,118272,159200,159198,159196,118288,159184,159182,159180,118304,159168,159166,159164,118320
.long 159152,159150,159148,118336,159136,159134,159132,118352,159120,159118,159116,118368,159104,159102,159100,118384
.long 159088,159086,159084,118400,159072,159070,159068,118416,159056,159054,159052,118432,159040,159038,159036,118448
.long 159024,159022,159020,118464,159008,159006,159004,118480,158992,158990,158988,118496,158974,158970,158966,118512
.long 158942,158938,158934,118528,158910,158906,158902,118544,158878,158874,158870,118560,158846,158842,158838,118576
.long 158814,158810,158806,118592,158782,158778,158774,118608,158750,158746,158742,118624,158714,158706,158698,118640
.long 158650,158642,158634,118656,158586,158578,158570,118672,158522,158514,158506,118688,158450,158434,158418,118704
.long 158322,158306,158290,118720,158178,158146,158114,118736,157890,157826,157762,118752,160004,160004,160004,118768
.section .rodata,"a"
.p2align 6
.amdhsa_kernel parallel_sum__ssm_conv_s4d__glu_gated_swiglu__prompt_kernel
  .amdhsa_next_free_vgpr 256
  .amdhsa_next_free_sgpr 102
  .amdhsa_accum_offset 256
  .amdhsa_group_segment_fixed_size 0
  .amdhsa_kernarg_size 112
  .amdhsa_user_sgpr_count 2
  .amdhsa_user_sgpr_kernarg_segment_ptr 1
  .amdhsa_system_sgpr_workgroup_id_x 1
.end_amdhsa_kernel
```
